```python
import torch

def _softmax(x, axis=-1):
    return torch.softmax(x, dim=axis)
def _gelu(x):
    return torch.nn.functional.gelu(x, approximate="tanh")
def _silu(x):
    return torch.nn.functional.silu(x)
def _sigmoid(x):
    return torch.sigmoid(x)
def _layernorm(x, axis=-1, eps=1e-5):
    m = x.mean(dim=axis, keepdim=True)
    v = x.var(dim=axis, keepdim=True, unbiased=False)
    return (x - m) / torch.sqrt(v + eps)
def _scatter_add(tgt, idx, src, axis=0):
    return tgt.clone().index_add_(axis, idx, src)
def _segment_sum(src, seg, n):
    out = torch.zeros((n,) + src.shape[1:], dtype=src.dtype)
    return out.index_add_(0, seg, src)
def _pad(x, pw):
    flat = tuple(v for pair in reversed(pw) for v in pair)
    return torch.nn.functional.pad(x, flat)

kernel_name = 'parallel_sum__ssm_conv_h3__glu_gated_geglu__prompt'

def setup_inputs():

    _w = (lambda a: (lambda t: t.to(torch.bfloat16) if t.is_floating_point() else t)(torch.as_tensor(a)))
    def _A_setup():
        B, S, D = 1, 2048, 640
        ks = 4
        return {
            "q": _w((lambda *s: torch.randn(*s, dtype=torch.bfloat16) * 0.05)(B, S, D)),
            "k": _w((lambda *s: torch.randn(*s, dtype=torch.bfloat16) * 0.2)(B, S, D)),
            "v": _w((lambda *s: torch.randn(*s, dtype=torch.bfloat16) * 0.2)(B, S, D)),
            "shift_k": _w((lambda *s: torch.randn(*s, dtype=torch.bfloat16) * 0.2)(D, ks) * 0.5),
            "ssm_k": _w((lambda *s: torch.randn(*s, dtype=torch.bfloat16) * 0.4)(D, S) * (1.0 / S ** 0.5)),
            "ssm_D": _w((lambda *s: torch.randn(*s, dtype=torch.bfloat16) * 0.2)(D)),
        }
    _A_in = _A_setup()

    def _B_setup():
        B, S, Dm, Df = 1, 2048, 640, 1728
        return {
            "x": _w((lambda *s: torch.randn(*s, dtype=torch.bfloat16) * 0.05)(B, S, Dm)),
            "w_gate": _w((lambda *s: torch.randn(*s, dtype=torch.bfloat16) * 0.4)(Dm, Df) * (Dm ** -0.5)),
            "w_up": _w((lambda *s: torch.randn(*s, dtype=torch.bfloat16) * 0.4)(Dm, Df) * (Dm ** -0.5)),
            "w_down": _w((lambda *s: torch.randn(*s, dtype=torch.bfloat16) * 0.4)(Df, Dm) * (Df ** -0.5)),
        }
    _B_in = _B_setup()

    return {
        "A_q": _A_in["q"],
        "A_k": _A_in["k"],
        "A_v": _A_in["v"],
        "A_shift_k": _A_in["shift_k"],
        "A_ssm_k": _A_in["ssm_k"],
        "A_ssm_D": _A_in["ssm_D"],
        "B_x": _B_in["x"],
        "B_w_gate": _B_in["w_gate"],
        "B_w_up": _B_in["w_up"],
        "B_w_down": _B_in["w_down"],
    }

def reference(A_q, A_k, A_v, A_shift_k, A_ssm_k, A_ssm_D, B_x, B_w_gate, B_w_up, B_w_down):
    def _A_ref(q, k, v, shift_k, ssm_k, ssm_D):
        B, S, D = q.shape
        ks = shift_k.shape[-1]
        k_pad = _pad(k, ((0, 0), (ks - 1, 0), (0, 0)))
        k_shift = torch.zeros_like(k)
        for t in range(ks):
            k_shift = k_shift + k_pad[:, t:t + S, :] * shift_k[:, ks - 1 - t][None, None, :]
        kv = k_shift * v
        L = 2 * S
        kv_pad = _pad(kv, ((0, 0), (0, S), (0, 0)))
        kf_pad = _pad(ssm_k, ((0, 0), (0, S)))
        kv_f = (lambda x, axes=(-2,-1): torch.fft.rfft2(x.float(), dim=axes))(kv_pad[:, None, :, :], axes=(1, 2))
        kf_f = (lambda x, axes=(-2,-1): torch.fft.rfft2(x.float(), dim=axes))(kf_pad[:, None, :], axes=(1, 2))
        kf_f = (lambda x, *d: x.permute(*d))(kf_f, 1, 2, 0)
        y_f = kv_f * kf_f[None, :, :, :]
        y = (lambda x, s, axes=(-2,-1): torch.fft.irfft2(x, s=s, dim=axes).to(torch.bfloat16))(y_f, (1, L), axes=(1, 2))[:, 0, :S, :]
        y = y + kv * ssm_D[None, None, :]
        return q * y

    def _B_ref(x, w_gate, w_up, w_down):
        g = torch.einsum("bsd,df->bsf", x, w_gate)
        u = torch.einsum("bsd,df->bsf", x, w_up)
        h = _gelu(g) * u
        return torch.einsum("bsf,fd->bsd", h, w_down)

    x = A_q
    xn = _layernorm(x, axis=-1)
    return x + _A_ref(xn, A_k, A_v, A_shift_k, A_ssm_k, A_ssm_D) + _B_ref(xn, B_w_gate, B_w_up, B_w_down)
```

```asm
; @launch kernel=fused_kernel grid=(256,1,1) block=(512,1,1) lds=163840
.amdgcn_target "amdgcn-amd-amdhsa--gfx950"
.text
.globl fused_kernel
.p2align 8
.type fused_kernel,@function
fused_kernel:
s_cmp_ge_u32 s2, 256
s_cbranch_scc1 L_end
s_load_dwordx16 s[48:63], s[0:1], 0
s_load_dwordx8 s[64:71], s[0:1], 64
s_load_dwordx2 s[72:73], s[0:1], 96
v_lshrrev_b32 v2, 6, v0
v_and_b32 v1, 63, v0
v_readfirstlane_b32 s3, v2
s_and_b32 s4, s2, 7
s_lshr_b32 s5, s2, 3
s_lshr_b32 s96, s4, 1
s_mul_i32 s97, s96, 27
s_add_u32 s97, s97, s5
s_lshr_b32 s35, s97, 2
s_and_b32 s97, s97, 3
s_and_b32 s98, s4, 1
s_lshl_b32 s98, s98, 2
s_add_u32 s34, s97, s98
s_lshl_b32 s36, s34, 2
s_add_u32 s36, s36, s96
s_lshr_b32 s37, s5, 2

s_getpc_b64 s[8:9]
L_pc0:
s_and_b32 s11, s5, 15
s_lshl_b32 s11, s11, 3
s_and_b32 s10, s3, 7
s_add_u32 s11, s11, s10
s_lshl_b32 s11, s11, 6

s_add_u32 s12, s11, 0
s_min_u32 s12, s12, L_end-L_pc0
s_load_dword s10, s[8:9], s12

s_add_u32 s13, s11, 8192
s_min_u32 s13, s13, L_end-L_pc0
s_load_dword s10, s[8:9], s13

s_add_u32 s14, s11, 16384
s_min_u32 s14, s14, L_end-L_pc0
s_load_dword s10, s[8:9], s14

s_add_u32 s15, s11, 24576
s_min_u32 s15, s15, L_end-L_pc0
s_load_dword s10, s[8:9], s15

s_add_u32 s16, s11, 32768
s_min_u32 s16, s16, L_end-L_pc0
s_load_dword s10, s[8:9], s16

s_mov_b32 s6, 0
s_mov_b32 s93, 0
v_and_b32 v2, 15, v1
v_lshrrev_b32 v3, 4, v1

s_and_b32 s96, s3, 3
v_lshrrev_b32 v4, 3, v1
v_and_b32 v5, 7, v1
s_lshl_b32 s101, s96, 4
v_add_u32 v6, s101, v4
v_mul_u32_u24 v6, 3456, v6
v_and_b32 v7, 1, v3
v_lshlrev_b32 v7, 1, v7
v_xor_b32 v7, v7, v5
v_xor_b32 v8, 4, v7
s_lshl_b32 s101, s35, 7
v_add_u32 v6, s101, v6
v_lshl_add_u32 v24, v7, 4, v6
v_lshl_add_u32 v25, v8, 4, v6
v_add_u32 v25, 26624, v25
s_lshl_b32 s32, s96, 13
s_lshl_b32 s33, s96, 11
s_lshl_b32 s100, s34, 8
s_lshl_b32 s101, s96, 6
s_add_u32 s83, s100, s101
v_add_u32 v6, s83, v4
v_mul_u32_u24 v6, 1280, v6
v_xor_b32 v7, v5, v3
v_xor_b32 v8, 4, v7
v_lshl_add_u32 v7, v7, 4, v6
v_lshl_add_u32 v8, v8, 4, v6

v_add_u32 v16, 0, v7
v_add_u32 v17, 9216, v8
v_add_u32 v18, 18432, v7
v_add_u32 v19, 27648, v8
v_add_u32 v20, 40960, v7
v_add_u32 v21, 50176, v8
v_add_u32 v22, 59392, v7
v_add_u32 v23, 68608, v8
s_and_b32 s101, s34, 3
s_add_u32 s101, s101, s35
s_mul_i32 s100, s101, 52
s_lshr_b32 s100, s100, 8
s_mul_i32 s100, s100, 5
s_sub_u32 s99, s101, s100

s_waitcnt lgkmcnt(0)
s_cmp_ge_u32 s5, 27
s_cbranch_scc1 L_prep0

s_mov_b32 s8, s48
s_mov_b32 s9, s49
s_mov_b32 s10, 2621440
s_mov_b32 s11, 0x00020000
s_mov_b32 s12, s62
s_mov_b32 s13, s63
s_mov_b32 s14, 2211840
s_mov_b32 s15, 0x00020000
s_mov_b32 s16, s64
s_mov_b32 s17, s65
s_mov_b32 s18, 2211840
s_mov_b32 s19, 0x00020000
s_mov_b32 s54, s99
s_cmp_ge_u32 s3, 4
s_cbranch_scc1 L_g1l0

s_mul_i32 s101, s54, 221184
s_add_u32 m0, s33, 32768
s_nop 0
buffer_load_dwordx4 v24, s[12:15], s101 offen offset:0 lds
buffer_load_dwordx4 v25, s[12:15], s101 offen offset:1024 lds
s_add_u32 m0, s33, 40960
s_nop 0
buffer_load_dwordx4 v24, s[16:19], s101 offen offset:0 lds
buffer_load_dwordx4 v25, s[16:19], s101 offen offset:1024 lds
s_lshl_b32 s100, s54, 7
s_add_u32 m0, s32, 0
s_nop 0
buffer_load_dwordx4 v16, s[8:11], s100 offen offset:0 lds
buffer_load_dwordx4 v17, s[8:11], s100 offen offset:1024 lds
buffer_load_dwordx4 v18, s[8:11], s100 offen offset:2048 lds
buffer_load_dwordx4 v19, s[8:11], s100 offen offset:3072 lds
s_add_u32 m0, s32, 4096
s_nop 0
buffer_load_dwordx4 v20, s[8:11], s100 offen offset:0 lds
buffer_load_dwordx4 v21, s[8:11], s100 offen offset:1024 lds
buffer_load_dwordx4 v22, s[8:11], s100 offen offset:2048 lds
buffer_load_dwordx4 v23, s[8:11], s100 offen offset:3072 lds
s_add_u32 s54, s54, 1
s_cmp_eq_u32 s54, 5
s_cselect_b32 s54, 0, s54
s_and_b32 s97, s5, 3
s_lshl_b32 s97, s97, 1
s_add_u32 s97, s97, s37
s_sub_u32 s98, s97, 7
s_cmp_ge_u32 s97, 7
s_cselect_b32 s97, s98, s97
s_mul_i32 s97, s97, 1
s_and_b32 s98, s3, 6
s_cmp_eq_u32 s98, 2
s_cselect_b32 s98, 6, 7
s_cmp_ge_u32 s97, s98
s_cselect_b32 s61, 0, s97
s_sub_u32 s0, s98, s61
s_sub_u32 s0, s0, 1
s_lshl_b32 s97, s98, 12
s_sub_u32 s1, 4096, s97
s_mul_i32 s97, s98, 20480
s_sub_u32 s60, 16384, s97

s_mov_b32 s40, s70
s_mov_b32 s41, s71
s_mov_b32 s42, 256
s_mov_b32 s43, 0x00020000
s_mov_b32 s24, s72
s_mov_b32 s25, s73
s_mov_b32 s26, 20594688
s_mov_b32 s27, 0x00020000
s_branch L_g1c
L_prep0:
s_and_b32 s97, s5, 3
s_lshl_b32 s97, s97, 1
s_add_u32 s97, s97, s37
s_sub_u32 s98, s97, 7
s_cmp_ge_u32 s97, 7
s_cselect_b32 s97, s98, s97
s_mul_i32 s97, s97, 1
s_and_b32 s98, s3, 6
s_cmp_eq_u32 s98, 2
s_cselect_b32 s98, 6, 7
s_cmp_ge_u32 s97, s98
s_cselect_b32 s61, 0, s97
s_sub_u32 s0, s98, s61
s_sub_u32 s0, s0, 1
s_lshl_b32 s97, s98, 12
s_sub_u32 s1, 4096, s97
s_mul_i32 s97, s98, 20480
s_sub_u32 s60, 16384, s97

s_mov_b32 s40, s70
s_mov_b32 s41, s71
s_mov_b32 s42, 256
s_mov_b32 s43, 0x00020000
s_mov_b32 s24, s72
s_mov_b32 s25, s73
s_mov_b32 s26, 20594688
s_mov_b32 s27, 0x00020000
s_branch L_prep
L_g1l0:
s_and_b32 s97, s5, 3
s_lshl_b32 s97, s97, 1
s_add_u32 s97, s97, s37
s_sub_u32 s98, s97, 7
s_cmp_ge_u32 s97, 7
s_cselect_b32 s97, s98, s97
s_mul_i32 s97, s97, 1
s_and_b32 s98, s3, 6
s_cmp_eq_u32 s98, 2
s_cselect_b32 s98, 6, 7
s_cmp_ge_u32 s97, s98
s_cselect_b32 s61, 0, s97
s_sub_u32 s0, s98, s61
s_sub_u32 s0, s0, 1
s_lshl_b32 s97, s98, 12
s_sub_u32 s1, 4096, s97
s_mul_i32 s97, s98, 20480
s_sub_u32 s60, 16384, s97

s_mov_b32 s40, s70
s_mov_b32 s41, s71
s_mov_b32 s42, 256
s_mov_b32 s43, 0x00020000
s_mov_b32 s24, s72
s_mov_b32 s25, s73
s_mov_b32 s26, 20594688
s_mov_b32 s27, 0x00020000
s_add_u32 s54, s54, 1
s_cmp_eq_u32 s54, 5
s_cselect_b32 s54, 0, s54
s_mov_b32 s63, 0
s_mov_b32 s28, s66
s_mov_b32 s29, s67
s_mov_b32 s30, 2211840
s_mov_b32 s31, 0x00020000
s_cmp_ge_u32 s96, 2
s_cbranch_scc1 L_g1l_npk
s_mul_i32 s84, s4, 27
s_add_u32 s84, s84, s5
s_lshl_b32 s84, s84, 1
s_add_u32 s84, s84, s96
s_and_b32 s85, s84, 7
s_lshr_b32 s86, s84, 3
s_mul_i32 s84, s85, 54
s_add_u32 s84, s84, s86
s_mul_i32 s100, s85, 160

v_add_u32 v4, 0, v1
v_mul_u32_u24 v5, 205, v4
v_lshrrev_b32 v5, 11, v5
v_mul_u32_u24 v6, 10, v5
v_sub_u32 v6, v4, v6
v_mul_u32_u24 v7, 1280, v5
v_lshl_add_u32 v7, v6, 4, v7
v_add_u32 v7, s100, v7
v_subrev_u32 v70, 0, v7

v_add_u32 v4, 64, v1
v_mul_u32_u24 v5, 205, v4
v_lshrrev_b32 v5, 11, v5
v_mul_u32_u24 v6, 10, v5
v_sub_u32 v6, v4, v6
v_mul_u32_u24 v7, 1280, v5
v_lshl_add_u32 v7, v6, 4, v7
v_add_u32 v7, s100, v7
v_subrev_u32 v71, 1024, v7

v_add_u32 v4, 128, v1
v_mul_u32_u24 v5, 205, v4
v_lshrrev_b32 v5, 11, v5
v_mul_u32_u24 v6, 10, v5
v_sub_u32 v6, v4, v6
v_mul_u32_u24 v7, 1280, v5
v_lshl_add_u32 v7, v6, 4, v7
v_add_u32 v7, s100, v7
v_subrev_u32 v72, 2048, v7

v_add_u32 v4, 192, v1
v_mul_u32_u24 v5, 205, v4
v_lshrrev_b32 v5, 11, v5
v_mul_u32_u24 v6, 10, v5
v_sub_u32 v6, v4, v6
v_mul_u32_u24 v7, 1280, v5
v_lshl_add_u32 v7, v6, 4, v7
v_add_u32 v7, s100, v7
v_subrev_u32 v73, 3072, v7

v_add_u32 v4, 256, v1
v_mul_u32_u24 v5, 205, v4
v_lshrrev_b32 v5, 11, v5
v_mul_u32_u24 v6, 10, v5
v_sub_u32 v6, v4, v6
v_mul_u32_u24 v7, 1280, v5
v_lshl_add_u32 v7, v6, 4, v7
v_add_u32 v7, s100, v7
v_subrev_u32 v74, 0, v7

s_mul_i32 s100, s86, 40960
s_mul_i32 s101, s96, 5120
s_add_u32 m0, s101, 147456

s_nop 0
buffer_load_dwordx4 v70, s[28:31], s100 offen offset:0 lds
buffer_load_dwordx4 v71, s[28:31], s100 offen offset:1024 lds
buffer_load_dwordx4 v72, s[28:31], s100 offen offset:2048 lds
buffer_load_dwordx4 v73, s[28:31], s100 offen offset:3072 lds
s_add_u32 m0, s101, 151552
s_nop 0
buffer_load_dwordx4 v74, s[28:31], s100 offen lds
v_lshrrev_b32 v4, 2, v2
v_lshl_add_u32 v4, v3, 2, v4
v_and_b32 v5, 3, v2
v_lshlrev_b32 v5, 3, v5
v_mul_u32_u24 v75, 160, v4
s_add_u32 s101, s101, 147456
v_add3_u32 v75, v75, v5, s101
v_add_u32 v76, v75, v5
s_lshl_b32 s85, s85, 8
s_lshl_b32 s86, s86, 2
s_add_u32 s85, s85, s86
s_add_u32 s85, s85, 17924096
s_mul_i32 s84, s84, 5120
s_add_u32 s84, s84, 18382848
L_g1l_npk:

s_mov_b32 s62, s5
s_lshr_b32 s100, s4, 1
s_lshl_b32 s100, s100, 3
s_lshr_b32 s100, 0x2f1f0ff, s100
s_and_b32 s101, s100, 15
s_bfe_u32 s100, s100, 0x40004
s_cmp_eq_u32 s101, 15
s_cselect_b32 s101, 25, s101
s_cmp_eq_u32 s100, 15
s_cselect_b32 s100, 26, s100
s_cmp_eq_u32 s5, s101
s_cselect_b32 s62, 25, s62
s_cmp_eq_u32 s5, s100
s_cselect_b32 s62, 26, s62
s_cmp_eq_u32 s5, 25
s_cselect_b32 s62, s101, s62
s_cmp_eq_u32 s5, 26
s_cselect_b32 s62, s100, s62

s_cmp_lg_u32 s3, 4
s_cbranch_scc1 L_g1l_np
s_cmp_lt_u32 s62, 25
s_cselect_b32 s100, 0, 1000
v_mov_b32 v4, 163264
v_mov_b32 v8, s100
v_mov_b32 v9, s100
v_mov_b32 v10, s100
v_mov_b32 v11, s100
ds_write_b128 v4, v[8:11]
v_mov_b32 v8, 1000
v_mov_b32 v9, 1000
v_mov_b32 v10, 1000
v_mov_b32 v11, 1000
ds_write_b128 v4, v[8:11] offset:16
v_mov_b32 v8, 0
v_mov_b32 v9, 0
v_mov_b32 v10, 0
v_mov_b32 v11, 0
ds_write_b128 v4, v[8:11] offset:48
v_mov_b32 v4, 162176
ds_write_b128 v4, v[8:11]
ds_write_b128 v4, v[8:11] offset:16
ds_write_b128 v4, v[8:11] offset:32
L_g1l_np:
v_lshrrev_b32 v4, 2, v2
v_lshl_add_u32 v4, v3, 3, v4
v_and_b32 v5, 3, v2
v_lshlrev_b32 v5, 3, v5
s_lshr_b32 s100, s96, 1
s_lshl_b32 s100, s100, 6
v_add_u32 v5, s100, v5
v_bfe_u32 v6, v2, 3, 1
v_lshlrev_b32 v6, 5, v6
v_xor_b32 v5, v5, v6
v_and_b32 v6, 1, v3
v_lshlrev_b32 v6, 6, v6
v_xor_b32 v5, v5, v6
v_lshl_add_u32 v26, v4, 7, v5
s_and_b32 s100, s96, 1
s_lshl_b32 s100, s100, 13
s_add_u32 s100, s100, 32768
v_add_u32 v26, s100, v26
v_xor_b32 v27, 32, v26
v_add_u32 v28, 98304, v26
v_add_u32 v29, 98304, v27
v_lshlrev_b32 v65, 2, v1
v_min_u32 v108, 31, v1
v_lshlrev_b32 v108, 8, v108
v_min_u32 v109, 53, v1
v_lshlrev_b32 v109, 2, v109
s_bfe_u32 s7, s3, 0x10001

v_mov_b32 v40, 0x3f803f80
v_mov_b32 v41, 0x3f803f80
v_mov_b32 v42, 0x3f803f80
v_mov_b32 v43, 0x3f803f80
s_and_b32 s39, s3, 1
s_lshl_b32 s100, s39, 8
s_lshl_b32 s101, s39, 11
v_add_u32 v6, 1, v2
v_and_b32 v113, 3, v6
v_lshrrev_b32 v6, 2, v6
v_lshlrev_b32 v6, 4, v6
v_cmp_ne_u32 vcc, 0, v113
v_mul_u32_u24 v113, 4160, v113
v_add_u32 v113, v113, v6
v_cndmask_b32 v6, 0, 16, vcc
v_add_u32 v113, v113, v6
v_lshlrev_b32 v6, 4, v3
v_sub_u32 v113, v113, v6
v_add_u32 v113, 48, v113
v_add_u32 v113, s100, v113
v_and_b32 v114, 1, v2
v_cmp_eq_u32 vcc, 1, v114
v_lshrrev_b32 v114, 1, v2
v_lshlrev_b32 v114, 6, v114
v_add_u32 v114, v114, v6
v_mov_b32 v6, 21792
v_mov_b32 v4, 17152
v_cndmask_b32 v6, v6, v4, vcc
v_sub_u32 v114, v6, v114
v_add_u32 v114, s100, v114
v_lshlrev_b32 v6, 7, v3
v_lshl_add_u32 v117, v2, 2, v6
v_add_u32 v117, s101, v117
v_sub_u32 v115, 19148, v117
v_add_u32 v117, 8192, v117
v_lshlrev_b32 v112, 4, v1
s_lshl_b32 s100, s39, 1
v_and_b32 v5, 1, v3
v_add_u32 v5, s100, v5
v_add_u32 v6, v2, v5
v_subrev_u32 v6, 16, v6
v_lshlrev_b32 v118, 2, v6
v_cmp_gt_i32 vcc, 0, v6
v_mov_b32 v6, 0x7fff0000
s_nop 0
v_cndmask_b32 v118, v118, v6, vcc
v_cmp_ne_u32 vcc, 0, v5
v_mul_u32_u24 v116, 4160, v5
s_nop 0
v_cndmask_b32 v6, 0, 16, vcc
v_add_u32 v116, v116, v6
v_lshl_add_u32 v116, v2, 2, v116
v_cmp_gt_u32 vcc, 32, v1
v_mov_b32 v6, 24880
v_mov_b32 v4, 20752
v_cndmask_b32 v6, v6, v4, vcc
v_add_u32 v119, v6, v112
s_lshl_b32 s100, s7, 3
s_add_u32 s100, s100, 163264
v_mov_b32 v12, s100

s_and_b32 s99, s3, 3
s_add_u32 s74, s99, 28
s_cmp_ge_u32 s3, 4
s_cselect_b32 s74, s99, s74

s_lshl_b32 s99, s61, 2
s_add_u32 s74, s74, s99
s_mul_i32 s91, s37, 54
s_add_u32 s91, s91, s74
s_mul_i32 s91, s91, 5120
s_add_u32 s91, s91, 18382848
s_lshl_b32 s92, s37, 8
s_add_u32 s92, s92, 17924096

s_mov_b32 s80, 0
s_and_b32 s100, s5, 3
s_lshl_b32 s100, s100, 2
s_add_u32 s100, s100, s96
s_mul_i32 s100, s100, 5760
s_mul_i32 s81, s37, 276480
s_add_u32 s81, s81, s100
s_add_u32 s81, s81, 18382848
v_lshlrev_b32 v106, 7, v1

s_mov_b32 s20, s56
s_mov_b32 s21, s57
s_mov_b32 s22, 2621440
s_mov_b32 s23, 0x00020000
s_mul_i32 s100, s4, 25
s_add_u32 s100, s100, s62
s_lshl_b32 s100, s100, 1
s_add_u32 s100, s100, 240
s_add_u32 s95, s100, s7
s_lshr_b32 s101, s100, 6
s_lshl_b32 s82, s101, 13
s_add_u32 s82, s82, 17580032
s_mul_i32 s94, s7, 25920
s_add_u32 s94, s94, 98304
s_mov_b32 s98, 1
v_add_u32 v68, s83, v1
v_lshlrev_b32 v68, 3, v68

s_lshl_b32 s100, s34, 8
s_lshl_b32 s101, s35, 4
s_add_u32 s100, s100, s101
s_lshl_b32 s101, s96, 2
s_add_u32 s100, s100, s101
v_add_u32 v105, s100, v3
v_lshlrev_b32 v104, 3, v105
v_mul_u32_u24 v105, 1280, v105
v_lshl_add_u32 v105, v2, 4, v105
s_waitcnt lgkmcnt(0)

s_barrier
s_mul_i32 s101, s54, 221184
s_add_u32 m0, s33, 131072
s_nop 0
buffer_load_dwordx4 v24, s[12:15], s101 offen offset:0 lds
buffer_load_dwordx4 v25, s[12:15], s101 offen offset:1024 lds
s_add_u32 m0, s33, 139264
s_nop 0
buffer_load_dwordx4 v24, s[16:19], s101 offen offset:0 lds
buffer_load_dwordx4 v25, s[16:19], s101 offen offset:1024 lds
s_lshl_b32 s100, s54, 7
s_add_u32 m0, s32, 98304
s_nop 0
buffer_load_dwordx4 v16, s[8:11], s100 offen offset:0 lds
buffer_load_dwordx4 v17, s[8:11], s100 offen offset:1024 lds
buffer_load_dwordx4 v18, s[8:11], s100 offen offset:2048 lds
buffer_load_dwordx4 v19, s[8:11], s100 offen offset:3072 lds
s_add_u32 m0, s32, 102400
s_nop 0
buffer_load_dwordx4 v20, s[8:11], s100 offen offset:0 lds
buffer_load_dwordx4 v21, s[8:11], s100 offen offset:1024 lds
buffer_load_dwordx4 v22, s[8:11], s100 offen offset:2048 lds
buffer_load_dwordx4 v23, s[8:11], s100 offen offset:3072 lds
s_add_u32 s54, s54, 1
s_cmp_eq_u32 s54, 5
s_cselect_b32 s54, 0, s54
s_barrier
buffer_load_dword v15, off, s[40:43], 0 sc1
s_mul_i32 s101, s54, 221184
s_add_u32 m0, s33, 81920
s_nop 0
buffer_load_dwordx4 v24, s[12:15], s101 offen offset:0 lds
buffer_load_dwordx4 v25, s[12:15], s101 offen offset:1024 lds
s_add_u32 m0, s33, 90112
s_nop 0
buffer_load_dwordx4 v24, s[16:19], s101 offen offset:0 lds
buffer_load_dwordx4 v25, s[16:19], s101 offen offset:1024 lds
s_cmp_ge_u32 s96, 2
s_cbranch_scc1 L_g1l_npk1
s_waitcnt vmcnt(17)

ds_read_b64_tr_b16 v[80:81], v76 offset:0
ds_read_b64_tr_b16 v[82:83], v76 offset:2560
ds_read_b64_tr_b16 v[84:85], v76 offset:8
ds_read_b64_tr_b16 v[86:87], v76 offset:2568
ds_read_b64_tr_b16 v[88:89], v76 offset:64
ds_read_b64_tr_b16 v[90:91], v76 offset:2624
ds_read_b64_tr_b16 v[92:93], v76 offset:72
ds_read_b64_tr_b16 v[94:95], v76 offset:2632
ds_read_b64_tr_b16 v[96:97], v75 offset:128
ds_read_b64_tr_b16 v[98:99], v75 offset:2688
s_waitcnt lgkmcnt(0)
buffer_store_dwordx4 v[80:83], v112, s[24:27], s84 offen offset:0 sc1
buffer_store_dwordx4 v[84:87], v112, s[24:27], s84 offen offset:1024 sc1
buffer_store_dwordx4 v[88:91], v112, s[24:27], s84 offen offset:2048 sc1
buffer_store_dwordx4 v[92:95], v112, s[24:27], s84 offen offset:3072 sc1
s_add_u32 s84, s84, 4096
buffer_store_dwordx4 v[96:99], v112, s[24:27], s84 offen sc1
L_g1l_npk1:
ds_read_b64_tr_b16 v[48:49], v26 offset:0
ds_read_b64_tr_b16 v[50:51], v26 offset:512
ds_read_b64_tr_b16 v[52:53], v27 offset:0
ds_read_b64_tr_b16 v[54:55], v27 offset:512
ds_read_b64_tr_b16 v[56:57], v26 offset:4096
ds_read_b64_tr_b16 v[58:59], v26 offset:4608
ds_read_b64_tr_b16 v[60:61], v27 offset:4096
ds_read_b64_tr_b16 v[62:63], v27 offset:4608
s_waitcnt lgkmcnt(6)
v_mfma_f32_16x16x32_bf16 v[32:35], v[48:51], v[40:43], 0
s_waitcnt lgkmcnt(4)
v_mfma_f32_16x16x32_bf16 v[36:39], v[52:55], v[40:43], 0
s_waitcnt lgkmcnt(2)
v_mfma_f32_16x16x32_bf16 v[32:35], v[56:59], v[40:43], v[32:35]
s_waitcnt lgkmcnt(0)
v_mfma_f32_16x16x32_bf16 v[36:39], v[60:63], v[40:43], v[36:39]
s_waitcnt vmcnt(10)
s_cmp_lt_u32 s96, 2
s_cbranch_scc1 L_wpk_1
s_waitcnt vmcnt(5)
L_wpk_1:
s_barrier
s_cmp_ge_u32 s62, 25
s_cbranch_scc1 L_g1l_nzc
v_mov_b32 v4, -1
v_mov_b32 v5, -1
v_mov_b32 v6, -1
v_mov_b32 v7, -1

s_lshl_b32 s100, s39, 11
s_lshl_b32 s101, s95, 12
s_add_u32 s100, s100, s101
s_add_u32 s100, s100, 7864320
buffer_store_dwordx4 v[4:7], v112, s[24:27], s100 offen sc1
buffer_store_dwordx4 v[4:7], v112, s[24:27], s100 offen offset:1024 sc1

L_g1l_nzc:
s_lshl_b32 s100, s54, 7
s_add_u32 m0, s32, 49152
s_nop 0
buffer_load_dwordx4 v16, s[8:11], s100 offen offset:0 lds
buffer_load_dwordx4 v17, s[8:11], s100 offen offset:1024 lds
buffer_load_dwordx4 v18, s[8:11], s100 offen offset:2048 lds
buffer_load_dwordx4 v19, s[8:11], s100 offen offset:3072 lds
s_add_u32 m0, s32, 53248
s_nop 0
buffer_load_dwordx4 v20, s[8:11], s100 offen offset:0 lds
buffer_load_dwordx4 v21, s[8:11], s100 offen offset:1024 lds
buffer_load_dwordx4 v22, s[8:11], s100 offen offset:2048 lds
buffer_load_dwordx4 v23, s[8:11], s100 offen offset:3072 lds
s_add_u32 s54, s54, 1
s_cmp_eq_u32 s54, 5
s_cselect_b32 s54, 0, s54
s_mul_i32 s101, s54, 221184
s_add_u32 m0, s33, 32768
s_nop 0
buffer_load_dwordx4 v24, s[12:15], s101 offen offset:0 lds
buffer_load_dwordx4 v25, s[12:15], s101 offen offset:1024 lds
s_add_u32 m0, s33, 40960
s_nop 0
buffer_load_dwordx4 v24, s[16:19], s101 offen offset:0 lds
buffer_load_dwordx4 v25, s[16:19], s101 offen offset:1024 lds
s_lshl_b32 s100, s54, 7
s_add_u32 m0, s32, 0
s_nop 0
buffer_load_dwordx4 v16, s[8:11], s100 offen offset:0 lds
buffer_load_dwordx4 v17, s[8:11], s100 offen offset:1024 lds
buffer_load_dwordx4 v18, s[8:11], s100 offen offset:2048 lds
buffer_load_dwordx4 v19, s[8:11], s100 offen offset:3072 lds
s_add_u32 m0, s32, 4096
s_nop 0
buffer_load_dwordx4 v20, s[8:11], s100 offen offset:0 lds
buffer_load_dwordx4 v21, s[8:11], s100 offen offset:1024 lds
buffer_load_dwordx4 v22, s[8:11], s100 offen offset:2048 lds
buffer_load_dwordx4 v23, s[8:11], s100 offen offset:3072 lds
s_add_u32 s54, s54, 1
s_cmp_eq_u32 s54, 5
s_cselect_b32 s54, 0, s54
s_lshl_b32 s99, s5, 2
s_add_u32 s99, s99, s96
v_lshlrev_b32 v44, 7, v1
s_cmp_ge_u32 s99, 80
s_cbranch_scc1 L_pf_f
s_mul_i32 s100, s4, 327680

v_mul_u32_u24 v45, 205, v1
v_lshrrev_b32 v45, 10, v45
v_mul_u32_u24 v44, 5, v45
v_sub_u32 v44, v1, v44
v_lshlrev_b32 v44, 7, v44
v_mul_u32_u24 v45, 1280, v45
v_add3_u32 v44, v44, v45, 0
v_add_u32 v44, 640, v44

s_cmp_ge_u32 s99, 40
s_cbranch_scc1 L_pf_v

s_mov_b32 s28, s50
s_mov_b32 s29, s51
s_mov_b32 s30, 2621440
s_mov_b32 s31, 0x00020000
s_mov_b32 s101, s99
s_branch L_pf_kv0
L_pf_v:

s_mov_b32 s28, s52
s_mov_b32 s29, s53
s_mov_b32 s30, 2621440
s_mov_b32 s31, 0x00020000
s_sub_u32 s101, s99, 40
L_pf_kv0:

s_cmp_ge_u32 s101, 22
s_cselect_b32 s100, 1073741824, s100
s_mul_i32 s101, s101, 15360
s_min_u32 s101, s101, 311040

s_branch L_pf_kv
L_pf_f:

s_mov_b32 s28, s56
s_mov_b32 s29, s57
s_mov_b32 s30, 2621440
s_mov_b32 s31, 0x00020000
s_mul_i32 s100, s4, 122880
s_sub_u32 s101, s99, 80
s_lshl_b32 s101, s101, 13
s_cmp_ge_u32 s101, 122880
s_cselect_b32 s101, 1073741824, s101
L_pf_kv:
s_add_u32 s100, s100, s101
buffer_load_dword v125, v44, s[28:31], s100 offen

ds_read_b64_tr_b16 v[48:49], v28 offset:0
ds_read_b64_tr_b16 v[50:51], v28 offset:512
ds_read_b64_tr_b16 v[52:53], v29 offset:0
ds_read_b64_tr_b16 v[54:55], v29 offset:512
ds_read_b64_tr_b16 v[56:57], v28 offset:4096
ds_read_b64_tr_b16 v[58:59], v28 offset:4608
ds_read_b64_tr_b16 v[60:61], v29 offset:4096
ds_read_b64_tr_b16 v[62:63], v29 offset:4608
s_waitcnt lgkmcnt(6)
v_mfma_f32_16x16x32_bf16 v[32:35], v[48:51], v[40:43], v[32:35]
s_waitcnt lgkmcnt(4)
v_mfma_f32_16x16x32_bf16 v[36:39], v[52:55], v[40:43], v[36:39]
s_waitcnt lgkmcnt(2)
v_mfma_f32_16x16x32_bf16 v[32:35], v[56:59], v[40:43], v[32:35]
s_waitcnt lgkmcnt(0)
v_mfma_f32_16x16x32_bf16 v[36:39], v[60:63], v[40:43], v[36:39]
s_waitcnt vmcnt(12)
v_readfirstlane_b32 s6, v15
s_cmp_lg_u32 s6, 0
s_cbranch_scc1 L_nond_3
s_mov_b32 s74, 8192
L_non_2:
buffer_load_dword v15, off, s[40:43], 0 sc1
s_waitcnt vmcnt(0)
v_readfirstlane_b32 s6, v15
s_sub_u32 s74, s74, 1
s_cmp_eq_u32 s74, 0
s_cbranch_scc1 L_nond_3
s_cmp_eq_u32 s6, 0
s_cbranch_scc1 L_non_2
L_nond_3:

v_mov_b32 v4, 163296
v_mov_b32 v5, s6
ds_write_b32 v4, v5
s_cmp_ge_u32 s96, 2
s_cbranch_scc1 L_g1l_npk3

v_mov_b32 v4, s6
s_mov_b64 exec, 1
buffer_store_dword v4, off, s[24:27], s85 sc1
s_mov_b64 exec, -1

L_g1l_npk3:
s_mul_i32 s100, s39, 2560
s_lshl_b32 s101, s95, 2
s_add_u32 s100, s100, s101
s_add_u32 s85, s100, 18055168

s_cmp_ge_u32 s62, 25
s_cselect_b32 s85, 17678080, s85
v_mov_b32 v4, s6
s_mov_b64 exec, 1
buffer_store_dword v4, off, s[24:27], s85 sc1
s_mov_b64 exec, -1

s_waitcnt lgkmcnt(0)
s_barrier
s_cmp_ge_u32 s35, 16
s_cselect_b32 s100, 1073741824, 0
buffer_load_dwordx4 v[80:83], v105, s[8:11], s100 offen offset:0
buffer_load_dwordx4 v[84:87], v105, s[8:11], s100 offen offset:256
buffer_load_dwordx4 v[88:91], v105, s[8:11], s100 offen offset:512
buffer_load_dwordx4 v[92:95], v105, s[8:11], s100 offen offset:768
buffer_load_dwordx4 v[96:99], v105, s[8:11], s100 offen offset:1024
s_mul_i32 s101, s54, 221184
s_add_u32 m0, s33, 131072
s_nop 0
buffer_load_dwordx4 v24, s[12:15], s101 offen offset:0 lds
buffer_load_dwordx4 v25, s[12:15], s101 offen offset:1024 lds
s_add_u32 m0, s33, 139264
s_nop 0
buffer_load_dwordx4 v24, s[16:19], s101 offen offset:0 lds
buffer_load_dwordx4 v25, s[16:19], s101 offen offset:1024 lds
s_lshl_b32 s100, s54, 7
s_add_u32 m0, s32, 98304
s_nop 0
buffer_load_dwordx4 v16, s[8:11], s100 offen offset:0 lds
buffer_load_dwordx4 v17, s[8:11], s100 offen offset:1024 lds
buffer_load_dwordx4 v18, s[8:11], s100 offen offset:2048 lds
buffer_load_dwordx4 v19, s[8:11], s100 offen offset:3072 lds
s_add_u32 m0, s32, 102400
s_nop 0
buffer_load_dwordx4 v20, s[8:11], s100 offen offset:0 lds
buffer_load_dwordx4 v21, s[8:11], s100 offen offset:1024 lds
buffer_load_dwordx4 v22, s[8:11], s100 offen offset:2048 lds
buffer_load_dwordx4 v23, s[8:11], s100 offen offset:3072 lds
s_add_u32 s54, s54, 1
s_cmp_eq_u32 s54, 5
s_cselect_b32 s54, 0, s54
s_add_u32 s54, s54, 5
ds_read_b64_tr_b16 v[48:49], v26 offset:49152
ds_read_b64_tr_b16 v[50:51], v26 offset:49664
ds_read_b64_tr_b16 v[52:53], v27 offset:49152
ds_read_b64_tr_b16 v[54:55], v27 offset:49664
ds_read_b64_tr_b16 v[56:57], v26 offset:53248
ds_read_b64_tr_b16 v[58:59], v26 offset:53760
ds_read_b64_tr_b16 v[60:61], v27 offset:53248
ds_read_b64_tr_b16 v[62:63], v27 offset:53760
s_waitcnt lgkmcnt(6)
v_mfma_f32_16x16x32_bf16 v[32:35], v[48:51], v[40:43], v[32:35]
s_waitcnt lgkmcnt(4)
v_mfma_f32_16x16x32_bf16 v[36:39], v[52:55], v[40:43], v[36:39]
s_waitcnt lgkmcnt(2)
v_mfma_f32_16x16x32_bf16 v[32:35], v[56:59], v[40:43], v[32:35]
s_waitcnt lgkmcnt(0)
v_mfma_f32_16x16x32_bf16 v[36:39], v[60:63], v[40:43], v[36:39]
s_waitcnt vmcnt(20)
s_cmp_lt_u32 s96, 2
s_cbranch_scc1 L_wpk_4
s_waitcnt vmcnt(19)
L_wpk_4:
s_barrier
s_mul_i32 s101, s54, 221184
s_add_u32 m0, s33, 81920
s_nop 0
buffer_load_dwordx4 v24, s[12:15], s101 offen offset:0 lds
buffer_load_dwordx4 v25, s[12:15], s101 offen offset:1024 lds
s_add_u32 m0, s33, 90112
s_nop 0
buffer_load_dwordx4 v24, s[16:19], s101 offen offset:0 lds
buffer_load_dwordx4 v25, s[16:19], s101 offen offset:1024 lds
s_lshl_b32 s100, s54, 7
s_add_u32 m0, s32, 49152
s_nop 0
buffer_load_dwordx4 v16, s[8:11], s100 offen offset:0 lds
buffer_load_dwordx4 v17, s[8:11], s100 offen offset:1024 lds
buffer_load_dwordx4 v18, s[8:11], s100 offen offset:2048 lds
buffer_load_dwordx4 v19, s[8:11], s100 offen offset:3072 lds
s_add_u32 m0, s32, 53248
s_nop 0
buffer_load_dwordx4 v20, s[8:11], s100 offen offset:0 lds
buffer_load_dwordx4 v21, s[8:11], s100 offen offset:1024 lds
buffer_load_dwordx4 v22, s[8:11], s100 offen offset:2048 lds
buffer_load_dwordx4 v23, s[8:11], s100 offen offset:3072 lds
s_add_u32 s54, s54, 1
s_cmp_eq_u32 s54, 10
s_cselect_b32 s54, 5, s54
ds_read_b64_tr_b16 v[48:49], v26 offset:0
ds_read_b64_tr_b16 v[50:51], v26 offset:512
ds_read_b64_tr_b16 v[52:53], v27 offset:0
ds_read_b64_tr_b16 v[54:55], v27 offset:512
ds_read_b64_tr_b16 v[56:57], v26 offset:4096
ds_read_b64_tr_b16 v[58:59], v26 offset:4608
ds_read_b64_tr_b16 v[60:61], v27 offset:4096
ds_read_b64_tr_b16 v[62:63], v27 offset:4608
s_waitcnt lgkmcnt(6)
v_mfma_f32_16x16x32_bf16 v[32:35], v[48:51], v[40:43], v[32:35]
s_waitcnt lgkmcnt(4)
v_mfma_f32_16x16x32_bf16 v[36:39], v[52:55], v[40:43], v[36:39]
s_waitcnt lgkmcnt(2)
v_mfma_f32_16x16x32_bf16 v[32:35], v[56:59], v[40:43], v[32:35]
s_waitcnt lgkmcnt(0)
v_mfma_f32_16x16x32_bf16 v[36:39], v[60:63], v[40:43], v[36:39]
s_waitcnt vmcnt(12)
s_barrier
s_mul_i32 s101, s54, 221184
s_add_u32 m0, s33, 32768
s_nop 0
buffer_load_dwordx4 v24, s[12:15], s101 offen offset:0 lds
buffer_load_dwordx4 v25, s[12:15], s101 offen offset:1024 lds
s_add_u32 m0, s33, 40960
s_nop 0
buffer_load_dwordx4 v24, s[16:19], s101 offen offset:0 lds
buffer_load_dwordx4 v25, s[16:19], s101 offen offset:1024 lds
s_lshl_b32 s100, s54, 7
s_add_u32 m0, s32, 0
s_nop 0
buffer_load_dwordx4 v16, s[8:11], s100 offen offset:0 lds
buffer_load_dwordx4 v17, s[8:11], s100 offen offset:1024 lds
buffer_load_dwordx4 v18, s[8:11], s100 offen offset:2048 lds
buffer_load_dwordx4 v19, s[8:11], s100 offen offset:3072 lds
s_add_u32 m0, s32, 4096
s_nop 0
buffer_load_dwordx4 v20, s[8:11], s100 offen offset:0 lds
buffer_load_dwordx4 v21, s[8:11], s100 offen offset:1024 lds
buffer_load_dwordx4 v22, s[8:11], s100 offen offset:2048 lds
buffer_load_dwordx4 v23, s[8:11], s100 offen offset:3072 lds
s_add_u32 s54, s54, 1
s_cmp_eq_u32 s54, 10
s_cselect_b32 s54, 5, s54
s_cmp_ge_u32 s35, 16
s_cbranch_scc1 L_g1l_ns1
s_mov_b32 s99, 0x3f803f80
v_mov_b32 v100, 0
v_mov_b32 v101, 0
v_mov_b32 v102, 0
v_mov_b32 v103, 0

v_dot2c_f32_bf16 v100, s99, v80
v_dot2c_f32_bf16 v102, v80, v80
v_dot2c_f32_bf16 v101, s99, v81
v_dot2c_f32_bf16 v103, v81, v81
v_dot2c_f32_bf16 v100, s99, v82
v_dot2c_f32_bf16 v102, v82, v82
v_dot2c_f32_bf16 v101, s99, v83
v_dot2c_f32_bf16 v103, v83, v83
v_dot2c_f32_bf16 v100, s99, v84
v_dot2c_f32_bf16 v102, v84, v84
v_dot2c_f32_bf16 v101, s99, v85
v_dot2c_f32_bf16 v103, v85, v85
v_dot2c_f32_bf16 v100, s99, v86
v_dot2c_f32_bf16 v102, v86, v86
v_dot2c_f32_bf16 v101, s99, v87
v_dot2c_f32_bf16 v103, v87, v87
v_dot2c_f32_bf16 v100, s99, v88
v_dot2c_f32_bf16 v102, v88, v88
v_dot2c_f32_bf16 v101, s99, v89
v_dot2c_f32_bf16 v103, v89, v89
v_dot2c_f32_bf16 v100, s99, v90
v_dot2c_f32_bf16 v102, v90, v90
v_dot2c_f32_bf16 v101, s99, v91
v_dot2c_f32_bf16 v103, v91, v91
v_dot2c_f32_bf16 v100, s99, v92
v_dot2c_f32_bf16 v102, v92, v92
v_dot2c_f32_bf16 v101, s99, v93
v_dot2c_f32_bf16 v103, v93, v93
v_dot2c_f32_bf16 v100, s99, v94
v_dot2c_f32_bf16 v102, v94, v94
v_dot2c_f32_bf16 v101, s99, v95
v_dot2c_f32_bf16 v103, v95, v95
v_dot2c_f32_bf16 v100, s99, v96
v_dot2c_f32_bf16 v102, v96, v96
v_dot2c_f32_bf16 v101, s99, v97
v_dot2c_f32_bf16 v103, v97, v97
v_dot2c_f32_bf16 v100, s99, v98
v_dot2c_f32_bf16 v102, v98, v98
v_dot2c_f32_bf16 v101, s99, v99
v_dot2c_f32_bf16 v103, v99, v99
s_nop 3
v_add_f32 v100, v100, v101
v_add_f32 v101, v102, v103
s_nop 0
v_add_f32_dpp v100, v100, v100 row_ror:8 row_mask:0xf bank_mask:0xf
v_add_f32_dpp v101, v101, v101 row_ror:8 row_mask:0xf bank_mask:0xf
s_nop 0
v_add_f32_dpp v100, v100, v100 row_ror:4 row_mask:0xf bank_mask:0xf
v_add_f32_dpp v101, v101, v101 row_ror:4 row_mask:0xf bank_mask:0xf
s_nop 0
v_add_f32_dpp v100, v100, v100 row_ror:2 row_mask:0xf bank_mask:0xf
v_add_f32_dpp v101, v101, v101 row_ror:2 row_mask:0xf bank_mask:0xf
s_nop 0
v_add_f32_dpp v100, v100, v100 row_ror:1 row_mask:0xf bank_mask:0xf
v_add_f32_dpp v101, v101, v101 row_ror:1 row_mask:0xf bank_mask:0xf
v_mul_f32 v100, 0.0015625, v100
v_mul_f32 v101, 0.0015625, v101
v_fma_f32 v101, -v100, v100, v101
v_max_f32 v101, 0, v101
v_cvt_pk_bf16_f32 v101, v101, v101
v_lshlrev_b32 v101, 16, v101
v_add_f32 v101, 0x3727c5ac, v101
v_cvt_pk_bf16_f32 v101, v101, v101
v_lshlrev_b32 v101, 16, v101
v_sqrt_f32 v101, v101
s_nop 0
v_cvt_pk_bf16_f32 v100, v100, v101
v_mov_b32 v101, s6
s_mov_b32 s100, 17563648
s_mov_b32 exec_lo, 0x00010001
s_mov_b32 exec_hi, 0x00010001
buffer_store_dwordx2 v[100:101], v104, s[24:27], s100 offen sc1
s_mov_b64 exec, -1
L_g1l_ns1:

ds_read_b64_tr_b16 v[48:49], v28 offset:0
ds_read_b64_tr_b16 v[50:51], v28 offset:512
ds_read_b64_tr_b16 v[52:53], v29 offset:0
ds_read_b64_tr_b16 v[54:55], v29 offset:512
ds_read_b64_tr_b16 v[56:57], v28 offset:4096
ds_read_b64_tr_b16 v[58:59], v28 offset:4608
ds_read_b64_tr_b16 v[60:61], v29 offset:4096
ds_read_b64_tr_b16 v[62:63], v29 offset:4608
s_waitcnt lgkmcnt(6)
v_mfma_f32_16x16x32_bf16 v[32:35], v[48:51], v[40:43], v[32:35]
s_waitcnt lgkmcnt(4)
v_mfma_f32_16x16x32_bf16 v[36:39], v[52:55], v[40:43], v[36:39]
s_waitcnt lgkmcnt(2)
v_mfma_f32_16x16x32_bf16 v[32:35], v[56:59], v[40:43], v[32:35]
s_waitcnt lgkmcnt(0)
v_mfma_f32_16x16x32_bf16 v[36:39], v[60:63], v[40:43], v[36:39]
s_waitcnt vmcnt(12)
s_barrier
buffer_load_dword v69, v109, s[24:27], s92 offen sc1
s_mul_i32 s101, s54, 221184
s_add_u32 m0, s33, 131072
s_nop 0
buffer_load_dwordx4 v24, s[12:15], s101 offen offset:0 lds
buffer_load_dwordx4 v25, s[12:15], s101 offen offset:1024 lds
s_add_u32 m0, s33, 139264
s_nop 0
buffer_load_dwordx4 v24, s[16:19], s101 offen offset:0 lds
buffer_load_dwordx4 v25, s[16:19], s101 offen offset:1024 lds
s_lshl_b32 s100, s54, 7
s_add_u32 m0, s32, 98304
s_nop 0
buffer_load_dwordx4 v16, s[8:11], s100 offen offset:0 lds
buffer_load_dwordx4 v17, s[8:11], s100 offen offset:1024 lds
buffer_load_dwordx4 v18, s[8:11], s100 offen offset:2048 lds
buffer_load_dwordx4 v19, s[8:11], s100 offen offset:3072 lds
s_add_u32 m0, s32, 102400
s_nop 0
buffer_load_dwordx4 v20, s[8:11], s100 offen offset:0 lds
buffer_load_dwordx4 v21, s[8:11], s100 offen offset:1024 lds
buffer_load_dwordx4 v22, s[8:11], s100 offen offset:2048 lds
buffer_load_dwordx4 v23, s[8:11], s100 offen offset:3072 lds
s_add_u32 s54, s54, 1
s_cmp_eq_u32 s54, 10
s_cselect_b32 s54, 5, s54
ds_read_b64_tr_b16 v[48:49], v26 offset:49152
ds_read_b64_tr_b16 v[50:51], v26 offset:49664
ds_read_b64_tr_b16 v[52:53], v27 offset:49152
ds_read_b64_tr_b16 v[54:55], v27 offset:49664
ds_read_b64_tr_b16 v[56:57], v26 offset:53248
ds_read_b64_tr_b16 v[58:59], v26 offset:53760
ds_read_b64_tr_b16 v[60:61], v27 offset:53248
ds_read_b64_tr_b16 v[62:63], v27 offset:53760
s_waitcnt lgkmcnt(6)
v_mfma_f32_16x16x32_bf16 v[32:35], v[48:51], v[40:43], v[32:35]
s_waitcnt lgkmcnt(4)
v_mfma_f32_16x16x32_bf16 v[36:39], v[52:55], v[40:43], v[36:39]
s_waitcnt lgkmcnt(2)
v_mfma_f32_16x16x32_bf16 v[32:35], v[56:59], v[40:43], v[32:35]
s_waitcnt lgkmcnt(0)
v_mfma_f32_16x16x32_bf16 v[36:39], v[60:63], v[40:43], v[36:39]
s_waitcnt vmcnt(13)
s_barrier
s_mul_i32 s101, s54, 221184
s_add_u32 m0, s33, 81920
s_nop 0
buffer_load_dwordx4 v24, s[12:15], s101 offen offset:0 lds
buffer_load_dwordx4 v25, s[12:15], s101 offen offset:1024 lds
s_add_u32 m0, s33, 90112
s_nop 0
buffer_load_dwordx4 v24, s[16:19], s101 offen offset:0 lds
buffer_load_dwordx4 v25, s[16:19], s101 offen offset:1024 lds
s_lshl_b32 s100, s54, 7
s_add_u32 m0, s32, 49152
s_nop 0
buffer_load_dwordx4 v16, s[8:11], s100 offen offset:0 lds
buffer_load_dwordx4 v17, s[8:11], s100 offen offset:1024 lds
buffer_load_dwordx4 v18, s[8:11], s100 offen offset:2048 lds
buffer_load_dwordx4 v19, s[8:11], s100 offen offset:3072 lds
s_add_u32 m0, s32, 53248
s_nop 0
buffer_load_dwordx4 v20, s[8:11], s100 offen offset:0 lds
buffer_load_dwordx4 v21, s[8:11], s100 offen offset:1024 lds
buffer_load_dwordx4 v22, s[8:11], s100 offen offset:2048 lds
buffer_load_dwordx4 v23, s[8:11], s100 offen offset:3072 lds
s_add_u32 s54, s54, 1
s_cmp_eq_u32 s54, 10
s_cselect_b32 s54, 5, s54
ds_read_b64_tr_b16 v[48:49], v26 offset:0
ds_read_b64_tr_b16 v[50:51], v26 offset:512
ds_read_b64_tr_b16 v[52:53], v27 offset:0
ds_read_b64_tr_b16 v[54:55], v27 offset:512
ds_read_b64_tr_b16 v[56:57], v26 offset:4096
ds_read_b64_tr_b16 v[58:59], v26 offset:4608
ds_read_b64_tr_b16 v[60:61], v27 offset:4096
ds_read_b64_tr_b16 v[62:63], v27 offset:4608
s_waitcnt lgkmcnt(6)
v_mfma_f32_16x16x32_bf16 v[32:35], v[48:51], v[40:43], v[32:35]
s_waitcnt lgkmcnt(4)
v_mfma_f32_16x16x32_bf16 v[36:39], v[52:55], v[40:43], v[36:39]
s_waitcnt lgkmcnt(2)
v_mfma_f32_16x16x32_bf16 v[32:35], v[56:59], v[40:43], v[32:35]
s_waitcnt lgkmcnt(0)
v_mfma_f32_16x16x32_bf16 v[36:39], v[60:63], v[40:43], v[36:39]
s_waitcnt vmcnt(12)
s_mov_b32 s74, 8192
L_wf_5:
v_cmp_ne_u32 vcc, s6, v69
s_and_b32 vcc_hi, vcc_hi, 0x3fffff
s_cmp_eq_u64 vcc, 0
s_cbranch_scc1 L_wfd_6
buffer_load_dword v69, v109, s[24:27], s92 offen sc1
s_waitcnt vmcnt(0)
s_sub_u32 s74, s74, 1
s_cmp_lg_u32 s74, 0
s_cbranch_scc1 L_wf_5
L_wfd_6:

s_barrier
s_mul_i32 s101, s54, 221184
s_add_u32 m0, s33, 32768
s_nop 0
buffer_load_dwordx4 v24, s[12:15], s101 offen offset:0 lds
buffer_load_dwordx4 v25, s[12:15], s101 offen offset:1024 lds
s_add_u32 m0, s33, 40960
s_nop 0
buffer_load_dwordx4 v24, s[16:19], s101 offen offset:0 lds
buffer_load_dwordx4 v25, s[16:19], s101 offen offset:1024 lds
s_lshl_b32 s100, s54, 7
s_add_u32 m0, s32, 0
s_nop 0
buffer_load_dwordx4 v16, s[8:11], s100 offen offset:0 lds
buffer_load_dwordx4 v17, s[8:11], s100 offen offset:1024 lds
buffer_load_dwordx4 v18, s[8:11], s100 offen offset:2048 lds
buffer_load_dwordx4 v19, s[8:11], s100 offen offset:3072 lds
s_add_u32 m0, s32, 4096
s_nop 0
buffer_load_dwordx4 v20, s[8:11], s100 offen offset:0 lds
buffer_load_dwordx4 v21, s[8:11], s100 offen offset:1024 lds
buffer_load_dwordx4 v22, s[8:11], s100 offen offset:2048 lds
buffer_load_dwordx4 v23, s[8:11], s100 offen offset:3072 lds
s_add_u32 s54, s54, 1
s_cmp_eq_u32 s54, 10
s_cselect_b32 s54, 5, s54
s_mov_b32 s100, 17563648
buffer_load_dwordx2 v[66:67], v68, s[24:27], s100 offen sc1
buffer_load_dwordx4 v[128:131], v112, s[24:27], s91 offen offset:0
buffer_load_dwordx4 v[132:135], v112, s[24:27], s91 offen offset:1024
buffer_load_dwordx4 v[136:139], v112, s[24:27], s91 offen offset:2048
buffer_load_dwordx4 v[140:143], v112, s[24:27], s91 offen offset:3072
s_add_u32 s91, s91, 4096
buffer_load_dwordx4 v[144:147], v112, s[24:27], s91 offen
s_cmp_eq_u32 s0, 0
s_cselect_b32 s99, s60, 16384
s_add_u32 s91, s91, s99
buffer_load_dwordx4 v[148:151], v112, s[24:27], s91 offen offset:0
ds_read_b64_tr_b16 v[48:49], v28 offset:0
ds_read_b64_tr_b16 v[50:51], v28 offset:512
ds_read_b64_tr_b16 v[52:53], v29 offset:0
ds_read_b64_tr_b16 v[54:55], v29 offset:512
ds_read_b64_tr_b16 v[56:57], v28 offset:4096
ds_read_b64_tr_b16 v[58:59], v28 offset:4608
ds_read_b64_tr_b16 v[60:61], v29 offset:4096
ds_read_b64_tr_b16 v[62:63], v29 offset:4608
s_waitcnt lgkmcnt(6)
v_mfma_f32_16x16x32_bf16 v[32:35], v[48:51], v[40:43], v[32:35]
s_waitcnt lgkmcnt(4)
v_mfma_f32_16x16x32_bf16 v[36:39], v[52:55], v[40:43], v[36:39]
s_waitcnt lgkmcnt(2)
v_mfma_f32_16x16x32_bf16 v[32:35], v[56:59], v[40:43], v[32:35]
s_waitcnt lgkmcnt(0)
v_mfma_f32_16x16x32_bf16 v[36:39], v[60:63], v[40:43], v[36:39]
s_waitcnt vmcnt(19)
s_barrier
buffer_load_dword v64, v108, s[24:27], s82 offen sc1
buffer_load_dwordx4 v[152:155], v112, s[24:27], s91 offen offset:1024
buffer_load_dwordx4 v[156:159], v112, s[24:27], s91 offen offset:2048
buffer_load_dwordx4 v[160:163], v112, s[24:27], s91 offen offset:3072
s_add_u32 s91, s91, 4096
buffer_load_dwordx4 v[164:167], v112, s[24:27], s91 offen
s_cmp_eq_u32 s0, 1
s_cselect_b32 s99, s60, 16384
s_add_u32 s91, s91, s99
buffer_load_dwordx4 v[168:171], v112, s[24:27], s91 offen offset:0
buffer_load_dwordx4 v[172:175], v112, s[24:27], s91 offen offset:1024
buffer_load_dwordx4 v[176:179], v112, s[24:27], s91 offen offset:2048
buffer_load_dwordx4 v[180:183], v112, s[24:27], s91 offen offset:3072
s_cmp_ge_u32 s62, 25
s_cbranch_scc1 L_g1l_c8n

s_lshl_b32 s100, s95, 12
buffer_load_dword v11, v118, s[20:23], s100 offen
s_lshl_b32 s101, s39, 3
s_add_u32 s100, s100, s101
s_mul_i32 s101, s39, 8336
s_add_u32 s101, s101, s94
s_add_u32 m0, s101, 64

s_nop 0
buffer_load_dwordx4 v112, s[20:23], s100 offen offset:0 lds
buffer_load_dwordx4 v112, s[20:23], s100 offen offset:1024 lds
buffer_load_dwordx4 v112, s[20:23], s100 offen offset:2048 lds
buffer_load_dwordx4 v112, s[20:23], s100 offen offset:3072 lds
s_lshl_b32 s74, s39, 4
s_sub_u32 s101, s101, s74
s_add_u32 m0, s101, 4240
s_add_u32 s100, s100, 4

buffer_load_dwordx4 v112, s[20:23], s100 offen offset:0 lds
buffer_load_dwordx4 v112, s[20:23], s100 offen offset:1024 lds
buffer_load_dwordx4 v112, s[20:23], s100 offen offset:2048 lds
buffer_load_dwordx4 v112, s[20:23], s100 offen offset:3072 lds
v_add_u32 v49, s94, v119
v_mov_b32 v76, 0
v_mov_b32 v77, 0
v_mov_b32 v78, 0
v_mov_b32 v79, 0
ds_write_b128 v49, v[76:79]

ds_read_b64_tr_b16 v[48:49], v26 offset:49152
ds_read_b64_tr_b16 v[50:51], v26 offset:49664
ds_read_b64_tr_b16 v[52:53], v27 offset:49152
ds_read_b64_tr_b16 v[54:55], v27 offset:49664
ds_read_b64_tr_b16 v[56:57], v26 offset:53248
ds_read_b64_tr_b16 v[58:59], v26 offset:53760
ds_read_b64_tr_b16 v[60:61], v27 offset:53248
ds_read_b64_tr_b16 v[62:63], v27 offset:53760
s_waitcnt lgkmcnt(6)
v_mfma_f32_16x16x32_bf16 v[32:35], v[48:51], v[40:43], v[32:35]
s_waitcnt lgkmcnt(4)
v_mfma_f32_16x16x32_bf16 v[36:39], v[52:55], v[40:43], v[36:39]
s_waitcnt lgkmcnt(2)
v_mfma_f32_16x16x32_bf16 v[32:35], v[56:59], v[40:43], v[32:35]
s_waitcnt lgkmcnt(0)
v_mfma_f32_16x16x32_bf16 v[36:39], v[60:63], v[40:43], v[36:39]
s_waitcnt vmcnt(17)
v_cmp_ne_u32 vcc, s6, v64
s_cmp_lg_u32 vcc_lo, 0
s_cbranch_scc1 L_g1l_c8d

s_lshl_b32 s100, s95, 12
s_lshr_b32 s101, s95, 6
s_lshl_b32 s101, s101, 6
s_add_u32 s101, s101, s39
s_lshl_b32 s101, s101, 1
s_add_u32 s100, s100, s101
s_add_u32 s100, s100, 2621440
s_mul_i32 s101, s39, 4640
s_add_u32 s101, s101, s94
s_add_u32 m0, s101, 16656

s_nop 0
buffer_load_dwordx4 v112, s[24:27], s100 offen offset:0 lds
buffer_load_dwordx4 v112, s[24:27], s100 offen offset:1024 lds
buffer_load_dwordx4 v112, s[24:27], s100 offen offset:2048 lds
buffer_load_dwordx4 v112, s[24:27], s100 offen offset:3072 lds
s_mov_b32 s98, 3
s_branch L_g1l_c8d
L_g1l_c8n:
ds_read_b64_tr_b16 v[48:49], v26 offset:49152
ds_read_b64_tr_b16 v[50:51], v26 offset:49664
ds_read_b64_tr_b16 v[52:53], v27 offset:49152
ds_read_b64_tr_b16 v[54:55], v27 offset:49664
ds_read_b64_tr_b16 v[56:57], v26 offset:53248
ds_read_b64_tr_b16 v[58:59], v26 offset:53760
ds_read_b64_tr_b16 v[60:61], v27 offset:53248
ds_read_b64_tr_b16 v[62:63], v27 offset:53760
s_waitcnt lgkmcnt(6)
v_mfma_f32_16x16x32_bf16 v[32:35], v[48:51], v[40:43], v[32:35]
s_waitcnt lgkmcnt(4)
v_mfma_f32_16x16x32_bf16 v[36:39], v[52:55], v[40:43], v[36:39]
s_waitcnt lgkmcnt(2)
v_mfma_f32_16x16x32_bf16 v[32:35], v[56:59], v[40:43], v[32:35]
s_waitcnt lgkmcnt(0)
v_mfma_f32_16x16x32_bf16 v[36:39], v[60:63], v[40:43], v[36:39]
s_waitcnt vmcnt(8)
L_g1l_c8d:
s_barrier
buffer_load_dword v64, v108, s[24:27], s82 offen sc1
s_add_u32 s91, s91, 4096
buffer_load_dwordx4 v[184:187], v112, s[24:27], s91 offen
s_cmp_eq_u32 s0, 2
s_cselect_b32 s99, s60, 16384
s_add_u32 s91, s91, s99
buffer_load_dwordx4 v[188:191], v112, s[24:27], s91 offen offset:0
buffer_load_dwordx4 v[192:195], v112, s[24:27], s91 offen offset:1024
buffer_load_dwordx4 v[196:199], v112, s[24:27], s91 offen offset:2048
buffer_load_dwordx4 v[200:203], v112, s[24:27], s91 offen offset:3072
s_add_u32 s91, s91, 4096
buffer_load_dwordx4 v[204:207], v112, s[24:27], s91 offen
s_cmp_eq_u32 s0, 3
s_cselect_b32 s99, s60, 16384
s_add_u32 s91, s91, s99
buffer_load_dwordx4 v[208:211], v112, s[24:27], s91 offen offset:0
buffer_load_dwordx4 v[212:215], v112, s[24:27], s91 offen offset:1024
ds_read_b64_tr_b16 v[48:49], v26 offset:0
ds_read_b64_tr_b16 v[50:51], v26 offset:512
ds_read_b64_tr_b16 v[52:53], v27 offset:0
ds_read_b64_tr_b16 v[54:55], v27 offset:512
ds_read_b64_tr_b16 v[56:57], v26 offset:4096
ds_read_b64_tr_b16 v[58:59], v26 offset:4608
ds_read_b64_tr_b16 v[60:61], v27 offset:4096
ds_read_b64_tr_b16 v[62:63], v27 offset:4608
s_waitcnt lgkmcnt(6)
v_mfma_f32_16x16x32_bf16 v[32:35], v[48:51], v[40:43], v[32:35]
s_waitcnt lgkmcnt(4)
v_mfma_f32_16x16x32_bf16 v[36:39], v[52:55], v[40:43], v[36:39]
s_waitcnt lgkmcnt(2)
v_mfma_f32_16x16x32_bf16 v[32:35], v[56:59], v[40:43], v[32:35]
s_waitcnt lgkmcnt(0)
v_mfma_f32_16x16x32_bf16 v[36:39], v[60:63], v[40:43], v[36:39]
s_mov_b32 s74, 8192
s_mov_b32 s100, 17563648
L_stc_7:
v_cmp_ne_u32 vcc, s6, v67
s_cmp_eq_u64 vcc, 0
s_cbranch_scc1 L_stok_8
buffer_load_dwordx2 v[66:67], v68, s[24:27], s100 offen sc1
s_waitcnt vmcnt(0)
s_sub_u32 s74, s74, 1
s_cmp_lg_u32 s74, 0
s_cbranch_scc1 L_stc_7
L_stok_8:

s_mov_b32 s101, 96768
s_cmp_eq_u32 s96, 0
s_cselect_b32 s101, 72192, s101
s_cmp_eq_u32 s96, 2
s_cselect_b32 s101, 159744, s101
s_cmp_eq_u32 s96, 3
s_cselect_b32 s101, 160768, s101
v_and_b32 v55, 0xffff0000, v66
v_lshlrev_b32 v52, 16, v66
v_rcp_f32 v54, v55
v_mul_f32 v55, v55, v55
v_xor_b32 v52, 0x80000000, v52
v_mul_f32 v53, 0xc0135761, v54
v_mul_f32 v56, v54, v54
v_mul_f32 v54, 0xbdd2d3e8, v54
v_mul_f32 v54, v54, v56
v_lshl_add_u32 v49, v1, 4, s101
ds_write_b128 v49, v[52:55]

s_lshr_b32 s101, s96, 1
s_lshl_b32 s101, s101, 7
s_and_b32 s100, s96, 1
s_lshl_b32 s100, s100, 8
s_add_u32 s100, s100, s101
s_add_u32 s100, s100, 163328
v_lshlrev_b32 v49, 4, v3
v_add_u32 v49, s100, v49
s_mov_b32 exec_lo, 0x00010001
s_mov_b32 exec_hi, 0x00010001
ds_write_b128 v49, v[32:35]
ds_write_b128 v49, v[36:39] offset:64
s_mov_b64 exec, -1
s_waitcnt lgkmcnt(0)
s_barrier

s_cmp_ge_u32 s62, 25
s_cbranch_scc1 L_g1l_gd
s_cmp_lg_u32 s98, 1
s_mov_b32 s98, 33
s_cbranch_scc1 L_g1l_gd
s_waitcnt vmcnt(8)
v_cmp_ne_u32 vcc, s6, v64
s_cmp_eq_u32 vcc_lo, 0
s_cbranch_scc1 L_g1l_g2

s_mov_b32 s74, 8192
s_mov_b32 exec_hi, 0
L_kvp_9:
buffer_load_dword v64, v108, s[24:27], s82 offen sc1
s_waitcnt vmcnt(0)
v_cmp_ne_u32 vcc, s6, v64
s_cmp_eq_u64 vcc, 0
s_cbranch_scc1 L_kvd_10
s_mov_b64 exec, vcc
s_sleep 4
s_sub_u32 s74, s74, 1
s_cmp_lg_u32 s74, 0
s_cbranch_scc1 L_kvp_9
L_kvd_10:
s_mov_b64 exec, -1

L_g1l_g2:
s_lshl_b32 s100, s95, 12
s_lshr_b32 s101, s95, 6
s_lshl_b32 s101, s101, 6
s_add_u32 s101, s101, s39
s_lshl_b32 s101, s101, 1
s_add_u32 s100, s100, s101
s_add_u32 s100, s100, 2621440
s_mul_i32 s101, s39, 4640
s_add_u32 s101, s101, s94
s_add_u32 m0, s101, 16656

s_nop 0
buffer_load_dwordx4 v112, s[24:27], s100 offen offset:0 lds
buffer_load_dwordx4 v112, s[24:27], s100 offen offset:1024 lds
buffer_load_dwordx4 v112, s[24:27], s100 offen offset:2048 lds
buffer_load_dwordx4 v112, s[24:27], s100 offen offset:3072 lds
s_mov_b32 s98, 5
L_g1l_gd:

buffer_load_dwordx4 v[216:219], v112, s[24:27], s91 offen offset:2048
buffer_load_dwordx4 v[220:223], v112, s[24:27], s91 offen offset:3072
s_add_u32 s91, s91, 4096
buffer_load_dwordx4 v[224:227], v112, s[24:27], s91 offen
s_cmp_eq_u32 s0, 4
s_cselect_b32 s99, s60, 16384
s_add_u32 s91, s91, s99
buffer_load_dwordx4 v[228:231], v112, s[24:27], s91 offen offset:0
buffer_load_dwordx4 v[232:235], v112, s[24:27], s91 offen offset:1024
buffer_load_dwordx4 v[236:239], v112, s[24:27], s91 offen offset:2048
buffer_load_dwordx4 v[240:243], v112, s[24:27], s91 offen offset:3072
s_add_u32 s91, s91, 4096
buffer_load_dwordx4 v[244:247], v112, s[24:27], s91 offen
s_cmp_eq_u32 s0, 5
s_cselect_b32 s99, s60, 16384
s_add_u32 s91, s91, s99
s_mul_i32 s93, s96, 24576
s_add_u32 s93, s93, 1024
s_mov_b32 s92, 4096
s_mov_b32 m0, s93

s_nop 0
buffer_load_dwordx4 v112, s[24:27], s91 offen offset:0 lds
buffer_load_dwordx4 v112, s[24:27], s91 offen offset:1024 lds
buffer_load_dwordx4 v112, s[24:27], s91 offen offset:2048 lds
buffer_load_dwordx4 v112, s[24:27], s91 offen offset:3072 lds
s_add_u32 m0, s93, 4096
s_add_u32 s100, s91, 4096
buffer_load_dwordx4 v112, s[24:27], s100 offen lds
s_cmp_ge_u32 s96, 2
s_cbranch_scc1 L_w7_n
s_add_u32 s100, s91, 143360
s_mov_b32 s101, 154624
s_cmp_eq_u32 s96, 1
s_cselect_b32 m0, 150528, s101

s_nop 0
buffer_load_dwordx4 v112, s[24:27], s100 offen offset:0 lds
buffer_load_dwordx4 v112, s[24:27], s100 offen offset:1024 lds
buffer_load_dwordx4 v112, s[24:27], s100 offen offset:2048 lds
buffer_load_dwordx4 v112, s[24:27], s100 offen offset:3072 lds
s_add_u32 s100, s100, 4096
s_mov_b32 s101, 158720
s_cmp_eq_u32 s96, 1
s_cselect_b32 m0, 162240, s101
s_nop 0
buffer_load_dwordx4 v112, s[24:27], s100 offen lds
L_w7_n:

s_and_b32 s99, s3, 3
s_add_u32 s74, s99, 28
s_cmp_ge_u32 s3, 4
s_cselect_b32 s74, s99, s74
s_mov_b32 s88, 0x1111111
s_mov_b32 s89, 0
s_lshl_b64 s[88:89], s[88:89], s74
s_and_b32 s89, s89, 0x3fffff
s_mul_i32 s101, s36, 221184
s_add_u32 s101, s101, 10485760
s_lshl_b32 s100, s99, 10
s_add_u32 s55, s101, s100
s_lshl_b32 s100, s74, 10
s_add_u32 s101, s101, s100
s_lshl_b32 s100, s61, 12
s_add_u32 s101, s101, s100

s_add_u32 s100, s99, 1
s_and_b32 s100, s100, 3
s_mul_i32 s74, s100, 55296
s_add_u32 s44, s101, s74
s_add_u32 s50, s55, s74
s_mul_i32 s74, s100, 15360
s_add_u32 s74, s74, 98304
s_mul_i32 s100, s100, 5120
s_mul_i32 vcc_lo, s99, 24576
s_add_u32 s100, s100, vcc_lo
s_cmp_ge_u32 s3, 4
s_cselect_b32 s74, s100, s74
v_lshl_add_u32 v121, v1, 4, s74

s_add_u32 s100, s99, 2
s_and_b32 s100, s100, 3
s_mul_i32 s74, s100, 55296
s_add_u32 s45, s101, s74
s_add_u32 s51, s55, s74
s_mul_i32 s74, s100, 15360
s_add_u32 s74, s74, 103424
s_mul_i32 s100, s100, 5120
s_mul_i32 vcc_lo, s99, 24576
s_add_u32 s100, s100, vcc_lo
s_cmp_ge_u32 s3, 4
s_cselect_b32 s74, s100, s74
v_lshl_add_u32 v122, v1, 4, s74

s_add_u32 s100, s99, 3
s_and_b32 s100, s100, 3
s_mul_i32 s74, s100, 55296
s_add_u32 s46, s101, s74
s_add_u32 s52, s55, s74
s_mul_i32 s74, s100, 15360
s_add_u32 s74, s74, 108544
s_mul_i32 s100, s100, 5120
s_mul_i32 vcc_lo, s99, 24576
s_add_u32 s100, s100, vcc_lo
s_cmp_ge_u32 s3, 4
s_cselect_b32 s74, s100, s74
v_lshl_add_u32 v123, v1, 4, s74

s_add_u32 s100, s99, 4
s_and_b32 s100, s100, 3
s_mul_i32 s74, s100, 55296
s_add_u32 s47, s101, s74
s_add_u32 s53, s55, s74
s_mul_i32 s74, s100, 15360
s_add_u32 s74, s74, 113664
s_mul_i32 s100, s100, 5120
s_mul_i32 vcc_lo, s99, 24576
s_add_u32 s100, s100, vcc_lo
s_cmp_ge_u32 s3, 4
s_cselect_b32 s74, s100, s74
v_lshl_add_u32 v124, v1, 4, s74

s_and_b32 s100, s5, 3
s_lshl_b32 s100, s100, 1
s_add_u32 s100, s100, s37
s_sub_u32 s101, s100, 7
s_cmp_ge_u32 s100, 7
s_cselect_b32 s100, s101, s100
s_mul_i32 s55, s100, 1

s_lshl_b32 s87, s36, 6
s_lshl_b32 s100, s99, 4
s_add_u32 s87, s87, s100

s_mov_b32 s86, 0
s_cmp_lt_u32 s62, 25
s_cbranch_scc1 L_g1l_cv
s_waitcnt vmcnt(0)

s_lshl_b32 s100, s96, 2
s_add_u32 s100, s100, 162176
v_mov_b32 v4, s100
s_waitcnt vmcnt(0)
ds_write_b32 v4, v4

v_mov_b32 v4, 163312
s_mov_b32 s74, 65536
L_epw_11:
ds_read_b128 v[8:11], v4
s_waitcnt lgkmcnt(0)
v_min_u32 v8, v8, v9
v_min3_u32 v8, v8, v10, v11
s_nop 0
v_readfirstlane_b32 s100, v8
s_cmp_lg_u32 s100, 0
s_cbranch_scc1 L_epd_12
s_sleep 1
s_sub_u32 s74, s74, 1
s_cmp_lg_u32 s74, 0
s_cbranch_scc1 L_epw_11
L_epd_12:

s_branch L_g2_lentry
L_g1l_cv:

s_or_b32 s98, s98, 256
s_mov_b32 s32, s95
s_mov_b32 s33, s94
s_mov_b32 s96, 0
s_mov_b32 s97, 1
s_branch L_conv

L_g1c:
s_mov_b32 s62, s5
s_lshr_b32 s100, s4, 1
s_lshl_b32 s100, s100, 3
s_lshr_b32 s100, 0x2f1f0ff, s100
s_and_b32 s101, s100, 15
s_bfe_u32 s100, s100, 0x40004
s_cmp_eq_u32 s101, 15
s_cselect_b32 s101, 25, s101
s_cmp_eq_u32 s100, 15
s_cselect_b32 s100, 26, s100
s_cmp_eq_u32 s5, s101
s_cselect_b32 s62, 25, s62
s_cmp_eq_u32 s5, s100
s_cselect_b32 s62, 26, s62
s_cmp_eq_u32 s5, 25
s_cselect_b32 s62, s101, s62
s_cmp_eq_u32 s5, 26
s_cselect_b32 s62, s100, s62

s_or_b32 s100, s2, s3
s_cmp_lg_u32 s100, 0
s_cbranch_scc1 L_g1c_np
s_memrealtime s[100:101]
s_waitcnt lgkmcnt(0)
s_max_u32 s100, s100, 1
v_mov_b32 v4, s100
s_mov_b64 exec, 1
buffer_store_dword v4, off, s[40:43], 0 sc1
s_mov_b64 exec, -1
L_g1c_np:

s_barrier
s_mov_b32 s16, s68
s_mov_b32 s17, s69
s_mov_b32 s18, 2621440
s_mov_b32 s19, 0x00020000
s_lshr_b32 s80, s3, 1
s_and_b32 s81, s3, 1
v_lshrrev_b32 v40, 1, v2
v_xor_b32 v40, v40, v3
v_lshlrev_b32 v41, 7, v2
s_lshl_b32 s100, s80, 14
v_add_u32 v41, s100, v41
v_lshl_add_u32 v4, v40, 4, v41
v_xor_b32 v40, 4, v40
v_lshl_add_u32 v5, v40, 4, v41
v_add_u32 v6, 98304, v4
v_add_u32 v7, 98304, v5
v_lshrrev_b32 v40, 2, v2
v_lshl_add_u32 v40, v3, 3, v40
v_and_b32 v41, 3, v2
v_lshlrev_b32 v41, 3, v41
s_lshl_b32 s100, s81, 6
v_add_u32 v41, s100, v41
v_bfe_u32 v42, v2, 3, 1
v_lshlrev_b32 v42, 5, v42
v_xor_b32 v41, v41, v42
v_and_b32 v42, 1, v3
v_lshlrev_b32 v42, 6, v42
v_xor_b32 v41, v41, v42
v_lshl_add_u32 v8, v40, 7, v41
v_add_u32 v8, 32768, v8
v_xor_b32 v9, 32, v8
v_add_u32 v10, 98304, v8
v_add_u32 v11, 98304, v9

s_and_b32 s99, s3, 3
s_add_u32 s74, s99, 28
s_cmp_ge_u32 s3, 4
s_cselect_b32 s74, s99, s74
s_mov_b32 s88, 0x1111111
s_mov_b32 s89, 0
s_lshl_b64 s[88:89], s[88:89], s74
s_and_b32 s89, s89, 0x3fffff
s_mul_i32 s101, s36, 221184
s_add_u32 s101, s101, 10485760
s_lshl_b32 s100, s99, 10
s_add_u32 s55, s101, s100
s_lshl_b32 s100, s74, 10
s_add_u32 s101, s101, s100
s_lshl_b32 s100, s61, 12
s_add_u32 s101, s101, s100

s_add_u32 s100, s99, 1
s_and_b32 s100, s100, 3
s_mul_i32 s74, s100, 55296
s_add_u32 s44, s101, s74
s_add_u32 s50, s55, s74
s_mul_i32 s74, s100, 15360
s_add_u32 s74, s74, 98304
s_mul_i32 s100, s100, 5120
s_mul_i32 vcc_lo, s99, 24576
s_add_u32 s100, s100, vcc_lo
s_cmp_ge_u32 s3, 4
s_cselect_b32 s74, s100, s74
v_lshl_add_u32 v121, v1, 4, s74

s_add_u32 s100, s99, 2
s_and_b32 s100, s100, 3
s_mul_i32 s74, s100, 55296
s_add_u32 s45, s101, s74
s_add_u32 s51, s55, s74
s_mul_i32 s74, s100, 15360
s_add_u32 s74, s74, 103424
s_mul_i32 s100, s100, 5120
s_mul_i32 vcc_lo, s99, 24576
s_add_u32 s100, s100, vcc_lo
s_cmp_ge_u32 s3, 4
s_cselect_b32 s74, s100, s74
v_lshl_add_u32 v122, v1, 4, s74

s_add_u32 s100, s99, 3
s_and_b32 s100, s100, 3
s_mul_i32 s74, s100, 55296
s_add_u32 s46, s101, s74
s_add_u32 s52, s55, s74
s_mul_i32 s74, s100, 15360
s_add_u32 s74, s74, 108544
s_mul_i32 s100, s100, 5120
s_mul_i32 vcc_lo, s99, 24576
s_add_u32 s100, s100, vcc_lo
s_cmp_ge_u32 s3, 4
s_cselect_b32 s74, s100, s74
v_lshl_add_u32 v123, v1, 4, s74

s_add_u32 s100, s99, 4
s_and_b32 s100, s100, 3
s_mul_i32 s74, s100, 55296
s_add_u32 s47, s101, s74
s_add_u32 s53, s55, s74
s_mul_i32 s74, s100, 15360
s_add_u32 s74, s74, 113664
s_mul_i32 s100, s100, 5120
s_mul_i32 vcc_lo, s99, 24576
s_add_u32 s100, s100, vcc_lo
s_cmp_ge_u32 s3, 4
s_cselect_b32 s74, s100, s74
v_lshl_add_u32 v124, v1, 4, s74

s_and_b32 s100, s5, 3
s_lshl_b32 s100, s100, 1
s_add_u32 s100, s100, s37
s_sub_u32 s101, s100, 7
s_cmp_ge_u32 s100, 7
s_cselect_b32 s100, s101, s100
s_mul_i32 s55, s100, 1

s_lshl_b32 s87, s36, 6
s_lshl_b32 s100, s99, 4
s_add_u32 s87, s87, s100

s_and_b32 s99, s3, 3
s_mul_i32 s100, s37, 160
v_lshlrev_b32 v112, 4, v1
v_add_u32 v40, s87, v2
v_mul_u32_u24 v113, 1280, v40
v_lshl_add_u32 v113, v3, 4, v113
v_add_u32 v113, s100, v113
v_lshrrev_b32 v40, 2, v2
v_lshl_add_u32 v40, v3, 3, v40
v_and_b32 v41, 3, v2
v_lshlrev_b32 v41, 3, v41
s_mul_i32 s101, s99, 24576
s_add_u32 s101, s101, 20480
v_lshl_add_u32 v114, v40, 5, v41
v_add_u32 v114, s101, v114

s_and_b32 s99, s3, 3
s_add_u32 s74, s99, 28
s_cmp_ge_u32 s3, 4
s_cselect_b32 s74, s99, s74

s_lshl_b32 s99, s61, 2
s_add_u32 s74, s74, s99
s_mul_i32 s91, s37, 54
s_add_u32 s91, s91, s74
s_mul_i32 s91, s91, 5120
s_add_u32 s91, s91, 18382848
s_lshl_b32 s92, s37, 8
s_add_u32 s92, s92, 17924096

s_waitcnt vmcnt(0)
s_barrier
ds_read_b64_tr_b16 v[16:17], v8 offset:0
ds_read_b64_tr_b16 v[18:19], v8 offset:512
ds_read_b128 v[32:35], v4 offset:0
ds_read_b64_tr_b16 v[20:21], v9 offset:0
ds_read_b64_tr_b16 v[22:23], v9 offset:512
ds_read_b64_tr_b16 v[24:25], v8 offset:8192
ds_read_b64_tr_b16 v[26:27], v8 offset:8704
ds_read_b64_tr_b16 v[28:29], v9 offset:8192
ds_read_b64_tr_b16 v[30:31], v9 offset:8704
ds_read_b128 v[36:39], v4 offset:2048
ds_read_b128 v[40:43], v4 offset:4096
ds_read_b128 v[44:47], v4 offset:6144
ds_read_b128 v[48:51], v4 offset:8192
ds_read_b128 v[52:55], v4 offset:10240
ds_read_b128 v[56:59], v4 offset:12288
ds_read_b128 v[60:63], v4 offset:14336
v_mov_b32 v15, 163296
s_waitcnt lgkmcnt(0)
v_mfma_f32_16x16x32_bf16 v[128:131], v[16:19], v[32:35], 0
ds_read_b64_tr_b16 v[64:65], v8 offset:4096
v_mfma_f32_16x16x32_bf16 v[132:135], v[20:23], v[32:35], 0
ds_read_b64_tr_b16 v[66:67], v8 offset:4608
v_mfma_f32_16x16x32_bf16 v[136:139], v[24:27], v[32:35], 0
v_mfma_f32_16x16x32_bf16 v[140:143], v[28:31], v[32:35], 0
ds_read_b128 v[80:83], v5 offset:0
v_mfma_f32_16x16x32_bf16 v[144:147], v[16:19], v[36:39], 0
ds_read_b64_tr_b16 v[68:69], v9 offset:4096
v_mfma_f32_16x16x32_bf16 v[148:151], v[20:23], v[36:39], 0
v_mfma_f32_16x16x32_bf16 v[152:155], v[24:27], v[36:39], 0
ds_read_b64_tr_b16 v[70:71], v9 offset:4608
v_mfma_f32_16x16x32_bf16 v[156:159], v[28:31], v[36:39], 0
ds_read_b64_tr_b16 v[72:73], v8 offset:12288
v_mfma_f32_16x16x32_bf16 v[160:163], v[16:19], v[40:43], 0
v_mfma_f32_16x16x32_bf16 v[164:167], v[20:23], v[40:43], 0
ds_read_b64_tr_b16 v[74:75], v8 offset:12800
v_mfma_f32_16x16x32_bf16 v[168:171], v[24:27], v[40:43], 0
ds_read_b64_tr_b16 v[76:77], v9 offset:12288
v_mfma_f32_16x16x32_bf16 v[172:175], v[28:31], v[40:43], 0
v_mfma_f32_16x16x32_bf16 v[176:179], v[16:19], v[44:47], 0
ds_read_b64_tr_b16 v[78:79], v9 offset:12800
v_mfma_f32_16x16x32_bf16 v[180:183], v[20:23], v[44:47], 0
ds_read_b128 v[84:87], v5 offset:2048
v_mfma_f32_16x16x32_bf16 v[184:187], v[24:27], v[44:47], 0
v_mfma_f32_16x16x32_bf16 v[188:191], v[28:31], v[44:47], 0
ds_read_b128 v[88:91], v5 offset:4096
v_mfma_f32_16x16x32_bf16 v[192:195], v[16:19], v[48:51], 0
ds_read_b128 v[92:95], v5 offset:6144
v_mfma_f32_16x16x32_bf16 v[196:199], v[20:23], v[48:51], 0
v_mfma_f32_16x16x32_bf16 v[200:203], v[24:27], v[48:51], 0
ds_read_b128 v[96:99], v5 offset:8192
v_mfma_f32_16x16x32_bf16 v[204:207], v[28:31], v[48:51], 0
ds_read_b128 v[100:103], v5 offset:10240
v_mfma_f32_16x16x32_bf16 v[208:211], v[16:19], v[52:55], 0
v_mfma_f32_16x16x32_bf16 v[212:215], v[20:23], v[52:55], 0
ds_read_b128 v[104:107], v5 offset:12288
v_mfma_f32_16x16x32_bf16 v[216:219], v[24:27], v[52:55], 0
ds_read_b128 v[108:111], v5 offset:14336
v_mfma_f32_16x16x32_bf16 v[220:223], v[28:31], v[52:55], 0
v_mfma_f32_16x16x32_bf16 v[224:227], v[16:19], v[56:59], 0
v_mfma_f32_16x16x32_bf16 v[228:231], v[20:23], v[56:59], 0
v_mfma_f32_16x16x32_bf16 v[232:235], v[24:27], v[56:59], 0
v_mfma_f32_16x16x32_bf16 v[236:239], v[28:31], v[56:59], 0
v_mfma_f32_16x16x32_bf16 v[240:243], v[16:19], v[60:63], 0
v_mfma_f32_16x16x32_bf16 v[244:247], v[20:23], v[60:63], 0
v_mfma_f32_16x16x32_bf16 v[248:251], v[24:27], v[60:63], 0
v_mfma_f32_16x16x32_bf16 v[252:255], v[28:31], v[60:63], 0
s_waitcnt lgkmcnt(0)
s_barrier
v_mfma_f32_16x16x32_bf16 v[128:131], v[64:67], v[80:83], v[128:131]
ds_read_b64_tr_b16 v[16:17], v10 offset:0
v_mfma_f32_16x16x32_bf16 v[132:135], v[68:71], v[80:83], v[132:135]
ds_read_b64_tr_b16 v[18:19], v10 offset:512
v_mfma_f32_16x16x32_bf16 v[136:139], v[72:75], v[80:83], v[136:139]
v_mfma_f32_16x16x32_bf16 v[140:143], v[76:79], v[80:83], v[140:143]
ds_read_b128 v[32:35], v6 offset:0
v_mfma_f32_16x16x32_bf16 v[144:147], v[64:67], v[84:87], v[144:147]
ds_read_b64_tr_b16 v[20:21], v11 offset:0
v_mfma_f32_16x16x32_bf16 v[148:151], v[68:71], v[84:87], v[148:151]
v_mfma_f32_16x16x32_bf16 v[152:155], v[72:75], v[84:87], v[152:155]
ds_read_b64_tr_b16 v[22:23], v11 offset:512
v_mfma_f32_16x16x32_bf16 v[156:159], v[76:79], v[84:87], v[156:159]
ds_read_b64_tr_b16 v[24:25], v10 offset:8192
v_mfma_f32_16x16x32_bf16 v[160:163], v[64:67], v[88:91], v[160:163]
v_mfma_f32_16x16x32_bf16 v[164:167], v[68:71], v[88:91], v[164:167]
ds_read_b64_tr_b16 v[26:27], v10 offset:8704
v_mfma_f32_16x16x32_bf16 v[168:171], v[72:75], v[88:91], v[168:171]
ds_read_b64_tr_b16 v[28:29], v11 offset:8192
v_mfma_f32_16x16x32_bf16 v[172:175], v[76:79], v[88:91], v[172:175]
v_mfma_f32_16x16x32_bf16 v[176:179], v[64:67], v[92:95], v[176:179]
ds_read_b64_tr_b16 v[30:31], v11 offset:8704
v_mfma_f32_16x16x32_bf16 v[180:183], v[68:71], v[92:95], v[180:183]
ds_read_b128 v[36:39], v6 offset:2048
v_mfma_f32_16x16x32_bf16 v[184:187], v[72:75], v[92:95], v[184:187]
v_mfma_f32_16x16x32_bf16 v[188:191], v[76:79], v[92:95], v[188:191]
ds_read_b128 v[40:43], v6 offset:4096
v_mfma_f32_16x16x32_bf16 v[192:195], v[64:67], v[96:99], v[192:195]
ds_read_b128 v[44:47], v6 offset:6144
v_mfma_f32_16x16x32_bf16 v[196:199], v[68:71], v[96:99], v[196:199]
v_mfma_f32_16x16x32_bf16 v[200:203], v[72:75], v[96:99], v[200:203]
ds_read_b128 v[48:51], v6 offset:8192
v_mfma_f32_16x16x32_bf16 v[204:207], v[76:79], v[96:99], v[204:207]
ds_read_b128 v[52:55], v6 offset:10240
v_mfma_f32_16x16x32_bf16 v[208:211], v[64:67], v[100:103], v[208:211]
v_mfma_f32_16x16x32_bf16 v[212:215], v[68:71], v[100:103], v[212:215]
ds_read_b128 v[56:59], v6 offset:12288
v_mfma_f32_16x16x32_bf16 v[216:219], v[72:75], v[100:103], v[216:219]
ds_read_b128 v[60:63], v6 offset:14336
v_mfma_f32_16x16x32_bf16 v[220:223], v[76:79], v[100:103], v[220:223]
v_mfma_f32_16x16x32_bf16 v[224:227], v[64:67], v[104:107], v[224:227]
v_mfma_f32_16x16x32_bf16 v[228:231], v[68:71], v[104:107], v[228:231]
v_mfma_f32_16x16x32_bf16 v[232:235], v[72:75], v[104:107], v[232:235]
v_mfma_f32_16x16x32_bf16 v[236:239], v[76:79], v[104:107], v[236:239]
v_mfma_f32_16x16x32_bf16 v[240:243], v[64:67], v[108:111], v[240:243]
v_mfma_f32_16x16x32_bf16 v[244:247], v[68:71], v[108:111], v[244:247]
v_mfma_f32_16x16x32_bf16 v[248:251], v[72:75], v[108:111], v[248:251]
v_mfma_f32_16x16x32_bf16 v[252:255], v[76:79], v[108:111], v[252:255]
s_waitcnt lgkmcnt(0)
v_mfma_f32_16x16x32_bf16 v[128:131], v[16:19], v[32:35], v[128:131]
ds_read_b64_tr_b16 v[64:65], v10 offset:4096
v_mfma_f32_16x16x32_bf16 v[132:135], v[20:23], v[32:35], v[132:135]
ds_read_b64_tr_b16 v[66:67], v10 offset:4608
v_mfma_f32_16x16x32_bf16 v[136:139], v[24:27], v[32:35], v[136:139]
v_mfma_f32_16x16x32_bf16 v[140:143], v[28:31], v[32:35], v[140:143]
ds_read_b128 v[80:83], v7 offset:0
v_mfma_f32_16x16x32_bf16 v[144:147], v[16:19], v[36:39], v[144:147]
ds_read_b64_tr_b16 v[68:69], v11 offset:4096
v_mfma_f32_16x16x32_bf16 v[148:151], v[20:23], v[36:39], v[148:151]
v_mfma_f32_16x16x32_bf16 v[152:155], v[24:27], v[36:39], v[152:155]
ds_read_b64_tr_b16 v[70:71], v11 offset:4608
v_mfma_f32_16x16x32_bf16 v[156:159], v[28:31], v[36:39], v[156:159]
ds_read_b64_tr_b16 v[72:73], v10 offset:12288
v_mfma_f32_16x16x32_bf16 v[160:163], v[16:19], v[40:43], v[160:163]
v_mfma_f32_16x16x32_bf16 v[164:167], v[20:23], v[40:43], v[164:167]
ds_read_b64_tr_b16 v[74:75], v10 offset:12800
v_mfma_f32_16x16x32_bf16 v[168:171], v[24:27], v[40:43], v[168:171]
ds_read_b64_tr_b16 v[76:77], v11 offset:12288
v_mfma_f32_16x16x32_bf16 v[172:175], v[28:31], v[40:43], v[172:175]
v_mfma_f32_16x16x32_bf16 v[176:179], v[16:19], v[44:47], v[176:179]
ds_read_b64_tr_b16 v[78:79], v11 offset:12800
v_mfma_f32_16x16x32_bf16 v[180:183], v[20:23], v[44:47], v[180:183]
ds_read_b128 v[84:87], v7 offset:2048
v_mfma_f32_16x16x32_bf16 v[184:187], v[24:27], v[44:47], v[184:187]
v_mfma_f32_16x16x32_bf16 v[188:191], v[28:31], v[44:47], v[188:191]
ds_read_b128 v[88:91], v7 offset:4096
v_mfma_f32_16x16x32_bf16 v[192:195], v[16:19], v[48:51], v[192:195]
ds_read_b128 v[92:95], v7 offset:6144
v_mfma_f32_16x16x32_bf16 v[196:199], v[20:23], v[48:51], v[196:199]
v_mfma_f32_16x16x32_bf16 v[200:203], v[24:27], v[48:51], v[200:203]
ds_read_b128 v[96:99], v7 offset:8192
v_mfma_f32_16x16x32_bf16 v[204:207], v[28:31], v[48:51], v[204:207]
ds_read_b128 v[100:103], v7 offset:10240
v_mfma_f32_16x16x32_bf16 v[208:211], v[16:19], v[52:55], v[208:211]
v_mfma_f32_16x16x32_bf16 v[212:215], v[20:23], v[52:55], v[212:215]
ds_read_b128 v[104:107], v7 offset:12288
v_mfma_f32_16x16x32_bf16 v[216:219], v[24:27], v[52:55], v[216:219]
ds_read_b128 v[108:111], v7 offset:14336
v_mfma_f32_16x16x32_bf16 v[220:223], v[28:31], v[52:55], v[220:223]
v_mfma_f32_16x16x32_bf16 v[224:227], v[16:19], v[56:59], v[224:227]
v_mfma_f32_16x16x32_bf16 v[228:231], v[20:23], v[56:59], v[228:231]
v_mfma_f32_16x16x32_bf16 v[232:235], v[24:27], v[56:59], v[232:235]
v_mfma_f32_16x16x32_bf16 v[236:239], v[28:31], v[56:59], v[236:239]
v_mfma_f32_16x16x32_bf16 v[240:243], v[16:19], v[60:63], v[240:243]
v_mfma_f32_16x16x32_bf16 v[244:247], v[20:23], v[60:63], v[244:247]
v_mfma_f32_16x16x32_bf16 v[248:251], v[24:27], v[60:63], v[248:251]
v_mfma_f32_16x16x32_bf16 v[252:255], v[28:31], v[60:63], v[252:255]
s_waitcnt lgkmcnt(0)
s_barrier
v_mfma_f32_16x16x32_bf16 v[128:131], v[64:67], v[80:83], v[128:131]
ds_read_b64_tr_b16 v[16:17], v8 offset:49152
v_mfma_f32_16x16x32_bf16 v[132:135], v[68:71], v[80:83], v[132:135]
ds_read_b64_tr_b16 v[18:19], v8 offset:49664
v_mfma_f32_16x16x32_bf16 v[136:139], v[72:75], v[80:83], v[136:139]
v_mfma_f32_16x16x32_bf16 v[140:143], v[76:79], v[80:83], v[140:143]
ds_read_b128 v[32:35], v4 offset:49152
v_mfma_f32_16x16x32_bf16 v[144:147], v[64:67], v[84:87], v[144:147]
ds_read_b64_tr_b16 v[20:21], v9 offset:49152
v_mfma_f32_16x16x32_bf16 v[148:151], v[68:71], v[84:87], v[148:151]
v_mfma_f32_16x16x32_bf16 v[152:155], v[72:75], v[84:87], v[152:155]
ds_read_b64_tr_b16 v[22:23], v9 offset:49664
v_mfma_f32_16x16x32_bf16 v[156:159], v[76:79], v[84:87], v[156:159]
ds_read_b64_tr_b16 v[24:25], v8 offset:57344
v_mfma_f32_16x16x32_bf16 v[160:163], v[64:67], v[88:91], v[160:163]
v_mfma_f32_16x16x32_bf16 v[164:167], v[68:71], v[88:91], v[164:167]
ds_read_b64_tr_b16 v[26:27], v8 offset:57856
v_mfma_f32_16x16x32_bf16 v[168:171], v[72:75], v[88:91], v[168:171]
ds_read_b64_tr_b16 v[28:29], v9 offset:57344
v_mfma_f32_16x16x32_bf16 v[172:175], v[76:79], v[88:91], v[172:175]
v_mfma_f32_16x16x32_bf16 v[176:179], v[64:67], v[92:95], v[176:179]
ds_read_b64_tr_b16 v[30:31], v9 offset:57856
v_mfma_f32_16x16x32_bf16 v[180:183], v[68:71], v[92:95], v[180:183]
ds_read_b128 v[36:39], v4 offset:51200
v_mfma_f32_16x16x32_bf16 v[184:187], v[72:75], v[92:95], v[184:187]
v_mfma_f32_16x16x32_bf16 v[188:191], v[76:79], v[92:95], v[188:191]
ds_read_b128 v[40:43], v4 offset:53248
v_mfma_f32_16x16x32_bf16 v[192:195], v[64:67], v[96:99], v[192:195]
ds_read_b128 v[44:47], v4 offset:55296
v_mfma_f32_16x16x32_bf16 v[196:199], v[68:71], v[96:99], v[196:199]
v_mfma_f32_16x16x32_bf16 v[200:203], v[72:75], v[96:99], v[200:203]
ds_read_b128 v[48:51], v4 offset:57344
v_mfma_f32_16x16x32_bf16 v[204:207], v[76:79], v[96:99], v[204:207]
ds_read_b128 v[52:55], v4 offset:59392
v_mfma_f32_16x16x32_bf16 v[208:211], v[64:67], v[100:103], v[208:211]
v_mfma_f32_16x16x32_bf16 v[212:215], v[68:71], v[100:103], v[212:215]
ds_read_b128 v[56:59], v4 offset:61440
v_mfma_f32_16x16x32_bf16 v[216:219], v[72:75], v[100:103], v[216:219]
ds_read_b128 v[60:63], v4 offset:63488
v_mfma_f32_16x16x32_bf16 v[220:223], v[76:79], v[100:103], v[220:223]
v_mfma_f32_16x16x32_bf16 v[224:227], v[64:67], v[104:107], v[224:227]
v_mfma_f32_16x16x32_bf16 v[228:231], v[68:71], v[104:107], v[228:231]
v_mfma_f32_16x16x32_bf16 v[232:235], v[72:75], v[104:107], v[232:235]
v_mfma_f32_16x16x32_bf16 v[236:239], v[76:79], v[104:107], v[236:239]
ds_read_b32 v12, v15
v_mfma_f32_16x16x32_bf16 v[240:243], v[64:67], v[108:111], v[240:243]
v_mfma_f32_16x16x32_bf16 v[244:247], v[68:71], v[108:111], v[244:247]
v_mfma_f32_16x16x32_bf16 v[248:251], v[72:75], v[108:111], v[248:251]
v_mfma_f32_16x16x32_bf16 v[252:255], v[76:79], v[108:111], v[252:255]
s_waitcnt lgkmcnt(0)
v_mfma_f32_16x16x32_bf16 v[128:131], v[16:19], v[32:35], v[128:131]
ds_read_b64_tr_b16 v[64:65], v8 offset:53248
v_mfma_f32_16x16x32_bf16 v[132:135], v[20:23], v[32:35], v[132:135]
ds_read_b64_tr_b16 v[66:67], v8 offset:53760
v_mfma_f32_16x16x32_bf16 v[136:139], v[24:27], v[32:35], v[136:139]
v_readfirstlane_b32 s6, v12

v_mfma_f32_16x16x32_bf16 v[140:143], v[28:31], v[32:35], v[140:143]
ds_read_b128 v[80:83], v5 offset:49152
v_mfma_f32_16x16x32_bf16 v[144:147], v[16:19], v[36:39], v[144:147]
ds_read_b64_tr_b16 v[68:69], v9 offset:53248
v_mfma_f32_16x16x32_bf16 v[148:151], v[20:23], v[36:39], v[148:151]
v_mfma_f32_16x16x32_bf16 v[152:155], v[24:27], v[36:39], v[152:155]
ds_read_b64_tr_b16 v[70:71], v9 offset:53760
v_mfma_f32_16x16x32_bf16 v[156:159], v[28:31], v[36:39], v[156:159]
ds_read_b64_tr_b16 v[72:73], v8 offset:61440
v_mfma_f32_16x16x32_bf16 v[160:163], v[16:19], v[40:43], v[160:163]
v_mfma_f32_16x16x32_bf16 v[164:167], v[20:23], v[40:43], v[164:167]
ds_read_b64_tr_b16 v[74:75], v8 offset:61952
v_mfma_f32_16x16x32_bf16 v[168:171], v[24:27], v[40:43], v[168:171]
ds_read_b64_tr_b16 v[76:77], v9 offset:61440
v_mfma_f32_16x16x32_bf16 v[172:175], v[28:31], v[40:43], v[172:175]
v_mfma_f32_16x16x32_bf16 v[176:179], v[16:19], v[44:47], v[176:179]
ds_read_b64_tr_b16 v[78:79], v9 offset:61952
v_mfma_f32_16x16x32_bf16 v[180:183], v[20:23], v[44:47], v[180:183]
ds_read_b128 v[84:87], v5 offset:51200
v_mfma_f32_16x16x32_bf16 v[184:187], v[24:27], v[44:47], v[184:187]
v_mfma_f32_16x16x32_bf16 v[188:191], v[28:31], v[44:47], v[188:191]
ds_read_b128 v[88:91], v5 offset:53248
v_mfma_f32_16x16x32_bf16 v[192:195], v[16:19], v[48:51], v[192:195]
ds_read_b128 v[92:95], v5 offset:55296
v_mfma_f32_16x16x32_bf16 v[196:199], v[20:23], v[48:51], v[196:199]
v_mfma_f32_16x16x32_bf16 v[200:203], v[24:27], v[48:51], v[200:203]
ds_read_b128 v[96:99], v5 offset:57344
v_mfma_f32_16x16x32_bf16 v[204:207], v[28:31], v[48:51], v[204:207]
ds_read_b128 v[100:103], v5 offset:59392
v_mfma_f32_16x16x32_bf16 v[208:211], v[16:19], v[52:55], v[208:211]
v_mfma_f32_16x16x32_bf16 v[212:215], v[20:23], v[52:55], v[212:215]
ds_read_b128 v[104:107], v5 offset:61440
v_mfma_f32_16x16x32_bf16 v[216:219], v[24:27], v[52:55], v[216:219]
ds_read_b128 v[108:111], v5 offset:63488
v_mfma_f32_16x16x32_bf16 v[220:223], v[28:31], v[52:55], v[220:223]
v_mfma_f32_16x16x32_bf16 v[224:227], v[16:19], v[56:59], v[224:227]
v_mfma_f32_16x16x32_bf16 v[228:231], v[20:23], v[56:59], v[228:231]
v_mfma_f32_16x16x32_bf16 v[232:235], v[24:27], v[56:59], v[232:235]
v_mfma_f32_16x16x32_bf16 v[236:239], v[28:31], v[56:59], v[236:239]
v_mfma_f32_16x16x32_bf16 v[240:243], v[16:19], v[60:63], v[240:243]
v_mfma_f32_16x16x32_bf16 v[244:247], v[20:23], v[60:63], v[244:247]
v_mfma_f32_16x16x32_bf16 v[248:251], v[24:27], v[60:63], v[248:251]
v_mfma_f32_16x16x32_bf16 v[252:255], v[28:31], v[60:63], v[252:255]
s_waitcnt lgkmcnt(0)
s_barrier
v_mfma_f32_16x16x32_bf16 v[128:131], v[64:67], v[80:83], v[128:131]
ds_read_b64_tr_b16 v[16:17], v8 offset:0
v_mfma_f32_16x16x32_bf16 v[132:135], v[68:71], v[80:83], v[132:135]
ds_read_b64_tr_b16 v[18:19], v8 offset:512
v_mfma_f32_16x16x32_bf16 v[136:139], v[72:75], v[80:83], v[136:139]
v_mfma_f32_16x16x32_bf16 v[140:143], v[76:79], v[80:83], v[140:143]
ds_read_b128 v[32:35], v4 offset:0
v_mfma_f32_16x16x32_bf16 v[144:147], v[64:67], v[84:87], v[144:147]
ds_read_b64_tr_b16 v[20:21], v9 offset:0
v_mfma_f32_16x16x32_bf16 v[148:151], v[68:71], v[84:87], v[148:151]
v_mfma_f32_16x16x32_bf16 v[152:155], v[72:75], v[84:87], v[152:155]
ds_read_b64_tr_b16 v[22:23], v9 offset:512
v_mfma_f32_16x16x32_bf16 v[156:159], v[76:79], v[84:87], v[156:159]
ds_read_b64_tr_b16 v[24:25], v8 offset:8192
v_mfma_f32_16x16x32_bf16 v[160:163], v[64:67], v[88:91], v[160:163]
v_mfma_f32_16x16x32_bf16 v[164:167], v[68:71], v[88:91], v[164:167]
ds_read_b64_tr_b16 v[26:27], v8 offset:8704
v_mfma_f32_16x16x32_bf16 v[168:171], v[72:75], v[88:91], v[168:171]
ds_read_b64_tr_b16 v[28:29], v9 offset:8192
v_mfma_f32_16x16x32_bf16 v[172:175], v[76:79], v[88:91], v[172:175]
v_mfma_f32_16x16x32_bf16 v[176:179], v[64:67], v[92:95], v[176:179]
ds_read_b64_tr_b16 v[30:31], v9 offset:8704
v_mfma_f32_16x16x32_bf16 v[180:183], v[68:71], v[92:95], v[180:183]
ds_read_b128 v[36:39], v4 offset:2048
v_mfma_f32_16x16x32_bf16 v[184:187], v[72:75], v[92:95], v[184:187]
v_mfma_f32_16x16x32_bf16 v[188:191], v[76:79], v[92:95], v[188:191]
ds_read_b128 v[40:43], v4 offset:4096
v_mfma_f32_16x16x32_bf16 v[192:195], v[64:67], v[96:99], v[192:195]
ds_read_b128 v[44:47], v4 offset:6144
v_mfma_f32_16x16x32_bf16 v[196:199], v[68:71], v[96:99], v[196:199]
v_mfma_f32_16x16x32_bf16 v[200:203], v[72:75], v[96:99], v[200:203]
ds_read_b128 v[48:51], v4 offset:8192
v_mfma_f32_16x16x32_bf16 v[204:207], v[76:79], v[96:99], v[204:207]
ds_read_b128 v[52:55], v4 offset:10240
v_mfma_f32_16x16x32_bf16 v[208:211], v[64:67], v[100:103], v[208:211]
v_mfma_f32_16x16x32_bf16 v[212:215], v[68:71], v[100:103], v[212:215]
ds_read_b128 v[56:59], v4 offset:12288
v_mfma_f32_16x16x32_bf16 v[216:219], v[72:75], v[100:103], v[216:219]
ds_read_b128 v[60:63], v4 offset:14336
v_mfma_f32_16x16x32_bf16 v[220:223], v[76:79], v[100:103], v[220:223]
v_mfma_f32_16x16x32_bf16 v[224:227], v[64:67], v[104:107], v[224:227]
v_mfma_f32_16x16x32_bf16 v[228:231], v[68:71], v[104:107], v[228:231]
v_mfma_f32_16x16x32_bf16 v[232:235], v[72:75], v[104:107], v[232:235]
v_mfma_f32_16x16x32_bf16 v[236:239], v[76:79], v[104:107], v[236:239]
v_mfma_f32_16x16x32_bf16 v[240:243], v[64:67], v[108:111], v[240:243]
v_mfma_f32_16x16x32_bf16 v[244:247], v[68:71], v[108:111], v[244:247]
v_mfma_f32_16x16x32_bf16 v[248:251], v[72:75], v[108:111], v[248:251]
v_mfma_f32_16x16x32_bf16 v[252:255], v[76:79], v[108:111], v[252:255]
s_waitcnt lgkmcnt(0)
v_mfma_f32_16x16x32_bf16 v[128:131], v[16:19], v[32:35], v[128:131]
ds_read_b64_tr_b16 v[64:65], v8 offset:4096
v_mfma_f32_16x16x32_bf16 v[132:135], v[20:23], v[32:35], v[132:135]
ds_read_b64_tr_b16 v[66:67], v8 offset:4608
v_mfma_f32_16x16x32_bf16 v[136:139], v[24:27], v[32:35], v[136:139]
v_mfma_f32_16x16x32_bf16 v[140:143], v[28:31], v[32:35], v[140:143]
ds_read_b128 v[80:83], v5 offset:0
v_mfma_f32_16x16x32_bf16 v[144:147], v[16:19], v[36:39], v[144:147]
ds_read_b64_tr_b16 v[68:69], v9 offset:4096
v_mfma_f32_16x16x32_bf16 v[148:151], v[20:23], v[36:39], v[148:151]
v_mfma_f32_16x16x32_bf16 v[152:155], v[24:27], v[36:39], v[152:155]
ds_read_b64_tr_b16 v[70:71], v9 offset:4608
v_mfma_f32_16x16x32_bf16 v[156:159], v[28:31], v[36:39], v[156:159]
ds_read_b64_tr_b16 v[72:73], v8 offset:12288
v_mfma_f32_16x16x32_bf16 v[160:163], v[16:19], v[40:43], v[160:163]
v_mfma_f32_16x16x32_bf16 v[164:167], v[20:23], v[40:43], v[164:167]
ds_read_b64_tr_b16 v[74:75], v8 offset:12800
v_mfma_f32_16x16x32_bf16 v[168:171], v[24:27], v[40:43], v[168:171]
ds_read_b64_tr_b16 v[76:77], v9 offset:12288
v_mfma_f32_16x16x32_bf16 v[172:175], v[28:31], v[40:43], v[172:175]
v_mfma_f32_16x16x32_bf16 v[176:179], v[16:19], v[44:47], v[176:179]
ds_read_b64_tr_b16 v[78:79], v9 offset:12800
v_mfma_f32_16x16x32_bf16 v[180:183], v[20:23], v[44:47], v[180:183]
ds_read_b128 v[84:87], v5 offset:2048
v_mfma_f32_16x16x32_bf16 v[184:187], v[24:27], v[44:47], v[184:187]
v_mfma_f32_16x16x32_bf16 v[188:191], v[28:31], v[44:47], v[188:191]
ds_read_b128 v[88:91], v5 offset:4096
v_mfma_f32_16x16x32_bf16 v[192:195], v[16:19], v[48:51], v[192:195]
ds_read_b128 v[92:95], v5 offset:6144
v_mfma_f32_16x16x32_bf16 v[196:199], v[20:23], v[48:51], v[196:199]
v_mfma_f32_16x16x32_bf16 v[200:203], v[24:27], v[48:51], v[200:203]
ds_read_b128 v[96:99], v5 offset:8192
v_mfma_f32_16x16x32_bf16 v[204:207], v[28:31], v[48:51], v[204:207]
ds_read_b128 v[100:103], v5 offset:10240
v_mfma_f32_16x16x32_bf16 v[208:211], v[16:19], v[52:55], v[208:211]
v_mfma_f32_16x16x32_bf16 v[212:215], v[20:23], v[52:55], v[212:215]
ds_read_b128 v[104:107], v5 offset:12288
v_mfma_f32_16x16x32_bf16 v[216:219], v[24:27], v[52:55], v[216:219]
ds_read_b128 v[108:111], v5 offset:14336
v_mfma_f32_16x16x32_bf16 v[220:223], v[28:31], v[52:55], v[220:223]
v_mfma_f32_16x16x32_bf16 v[224:227], v[16:19], v[56:59], v[224:227]
v_mfma_f32_16x16x32_bf16 v[228:231], v[20:23], v[56:59], v[228:231]
v_mfma_f32_16x16x32_bf16 v[232:235], v[24:27], v[56:59], v[232:235]
v_mfma_f32_16x16x32_bf16 v[236:239], v[28:31], v[56:59], v[236:239]
v_mfma_f32_16x16x32_bf16 v[240:243], v[16:19], v[60:63], v[240:243]
v_mfma_f32_16x16x32_bf16 v[244:247], v[20:23], v[60:63], v[244:247]
v_mfma_f32_16x16x32_bf16 v[248:251], v[24:27], v[60:63], v[248:251]
v_mfma_f32_16x16x32_bf16 v[252:255], v[28:31], v[60:63], v[252:255]
s_waitcnt lgkmcnt(0)
s_barrier
v_mfma_f32_16x16x32_bf16 v[128:131], v[64:67], v[80:83], v[128:131]
ds_read_b64_tr_b16 v[16:17], v10 offset:0
v_mfma_f32_16x16x32_bf16 v[132:135], v[68:71], v[80:83], v[132:135]
ds_read_b64_tr_b16 v[18:19], v10 offset:512
v_mfma_f32_16x16x32_bf16 v[136:139], v[72:75], v[80:83], v[136:139]
v_mfma_f32_16x16x32_bf16 v[140:143], v[76:79], v[80:83], v[140:143]
ds_read_b128 v[32:35], v6 offset:0
v_mfma_f32_16x16x32_bf16 v[144:147], v[64:67], v[84:87], v[144:147]
ds_read_b64_tr_b16 v[20:21], v11 offset:0
v_mfma_f32_16x16x32_bf16 v[148:151], v[68:71], v[84:87], v[148:151]
v_mfma_f32_16x16x32_bf16 v[152:155], v[72:75], v[84:87], v[152:155]
ds_read_b64_tr_b16 v[22:23], v11 offset:512
v_mfma_f32_16x16x32_bf16 v[156:159], v[76:79], v[84:87], v[156:159]
ds_read_b64_tr_b16 v[24:25], v10 offset:8192
v_mfma_f32_16x16x32_bf16 v[160:163], v[64:67], v[88:91], v[160:163]
v_mfma_f32_16x16x32_bf16 v[164:167], v[68:71], v[88:91], v[164:167]
ds_read_b64_tr_b16 v[26:27], v10 offset:8704
v_mfma_f32_16x16x32_bf16 v[168:171], v[72:75], v[88:91], v[168:171]
ds_read_b64_tr_b16 v[28:29], v11 offset:8192
v_mfma_f32_16x16x32_bf16 v[172:175], v[76:79], v[88:91], v[172:175]
v_mfma_f32_16x16x32_bf16 v[176:179], v[64:67], v[92:95], v[176:179]
ds_read_b64_tr_b16 v[30:31], v11 offset:8704
v_mfma_f32_16x16x32_bf16 v[180:183], v[68:71], v[92:95], v[180:183]
ds_read_b128 v[36:39], v6 offset:2048
v_mfma_f32_16x16x32_bf16 v[184:187], v[72:75], v[92:95], v[184:187]
v_mfma_f32_16x16x32_bf16 v[188:191], v[76:79], v[92:95], v[188:191]
ds_read_b128 v[40:43], v6 offset:4096
v_mfma_f32_16x16x32_bf16 v[192:195], v[64:67], v[96:99], v[192:195]
ds_read_b128 v[44:47], v6 offset:6144
v_mfma_f32_16x16x32_bf16 v[196:199], v[68:71], v[96:99], v[196:199]
v_mfma_f32_16x16x32_bf16 v[200:203], v[72:75], v[96:99], v[200:203]
ds_read_b128 v[48:51], v6 offset:8192
v_mfma_f32_16x16x32_bf16 v[204:207], v[76:79], v[96:99], v[204:207]
ds_read_b128 v[52:55], v6 offset:10240
v_mfma_f32_16x16x32_bf16 v[208:211], v[64:67], v[100:103], v[208:211]
v_mfma_f32_16x16x32_bf16 v[212:215], v[68:71], v[100:103], v[212:215]
ds_read_b128 v[56:59], v6 offset:12288
v_mfma_f32_16x16x32_bf16 v[216:219], v[72:75], v[100:103], v[216:219]
ds_read_b128 v[60:63], v6 offset:14336
v_mfma_f32_16x16x32_bf16 v[220:223], v[76:79], v[100:103], v[220:223]
v_mfma_f32_16x16x32_bf16 v[224:227], v[64:67], v[104:107], v[224:227]
v_mfma_f32_16x16x32_bf16 v[228:231], v[68:71], v[104:107], v[228:231]
v_mfma_f32_16x16x32_bf16 v[232:235], v[72:75], v[104:107], v[232:235]
v_mfma_f32_16x16x32_bf16 v[236:239], v[76:79], v[104:107], v[236:239]
v_mfma_f32_16x16x32_bf16 v[240:243], v[64:67], v[108:111], v[240:243]
v_mfma_f32_16x16x32_bf16 v[244:247], v[68:71], v[108:111], v[244:247]
v_mfma_f32_16x16x32_bf16 v[248:251], v[72:75], v[108:111], v[248:251]
v_mfma_f32_16x16x32_bf16 v[252:255], v[76:79], v[108:111], v[252:255]
s_waitcnt lgkmcnt(0)
v_mfma_f32_16x16x32_bf16 v[128:131], v[16:19], v[32:35], v[128:131]
ds_read_b64_tr_b16 v[64:65], v10 offset:4096
v_mfma_f32_16x16x32_bf16 v[132:135], v[20:23], v[32:35], v[132:135]
ds_read_b64_tr_b16 v[66:67], v10 offset:4608
v_mfma_f32_16x16x32_bf16 v[136:139], v[24:27], v[32:35], v[136:139]
v_mfma_f32_16x16x32_bf16 v[140:143], v[28:31], v[32:35], v[140:143]
ds_read_b128 v[80:83], v7 offset:0
v_mfma_f32_16x16x32_bf16 v[144:147], v[16:19], v[36:39], v[144:147]
ds_read_b64_tr_b16 v[68:69], v11 offset:4096
v_mfma_f32_16x16x32_bf16 v[148:151], v[20:23], v[36:39], v[148:151]
s_cmp_lg_u32 s3, 3
s_cbranch_scc1 L_pff_13
s_cmp_ge_u32 s62, 25
s_cbranch_scc1 L_pff_13

s_mov_b32 s20, s56
s_mov_b32 s21, s57
s_mov_b32 s22, 2621440
s_mov_b32 s23, 0x00020000
v_lshlrev_b32 v15, 7, v1
s_mul_i32 s100, s4, 25
s_add_u32 s100, s100, s62
s_lshl_b32 s100, s100, 13
s_add_u32 s100, s100, 983040
buffer_load_dword v125, v15, s[20:23], s100 offen
L_pff_13:

v_mfma_f32_16x16x32_bf16 v[152:155], v[24:27], v[36:39], v[152:155]
ds_read_b64_tr_b16 v[70:71], v11 offset:4608
v_mfma_f32_16x16x32_bf16 v[156:159], v[28:31], v[36:39], v[156:159]
ds_read_b64_tr_b16 v[72:73], v10 offset:12288
v_mfma_f32_16x16x32_bf16 v[160:163], v[16:19], v[40:43], v[160:163]
v_mfma_f32_16x16x32_bf16 v[164:167], v[20:23], v[40:43], v[164:167]
ds_read_b64_tr_b16 v[74:75], v10 offset:12800
v_mfma_f32_16x16x32_bf16 v[168:171], v[24:27], v[40:43], v[168:171]
ds_read_b64_tr_b16 v[76:77], v11 offset:12288
v_mfma_f32_16x16x32_bf16 v[172:175], v[28:31], v[40:43], v[172:175]
v_mfma_f32_16x16x32_bf16 v[176:179], v[16:19], v[44:47], v[176:179]
ds_read_b64_tr_b16 v[78:79], v11 offset:12800
v_mfma_f32_16x16x32_bf16 v[180:183], v[20:23], v[44:47], v[180:183]
ds_read_b128 v[84:87], v7 offset:2048
v_mfma_f32_16x16x32_bf16 v[184:187], v[24:27], v[44:47], v[184:187]
v_mfma_f32_16x16x32_bf16 v[188:191], v[28:31], v[44:47], v[188:191]
ds_read_b128 v[88:91], v7 offset:4096
v_mfma_f32_16x16x32_bf16 v[192:195], v[16:19], v[48:51], v[192:195]
ds_read_b128 v[92:95], v7 offset:6144
v_mfma_f32_16x16x32_bf16 v[196:199], v[20:23], v[48:51], v[196:199]
v_mfma_f32_16x16x32_bf16 v[200:203], v[24:27], v[48:51], v[200:203]
ds_read_b128 v[96:99], v7 offset:8192
v_mfma_f32_16x16x32_bf16 v[204:207], v[28:31], v[48:51], v[204:207]
ds_read_b128 v[100:103], v7 offset:10240
v_mfma_f32_16x16x32_bf16 v[208:211], v[16:19], v[52:55], v[208:211]
v_mfma_f32_16x16x32_bf16 v[212:215], v[20:23], v[52:55], v[212:215]
ds_read_b128 v[104:107], v7 offset:12288
v_mfma_f32_16x16x32_bf16 v[216:219], v[24:27], v[52:55], v[216:219]
ds_read_b128 v[108:111], v7 offset:14336
v_mfma_f32_16x16x32_bf16 v[220:223], v[28:31], v[52:55], v[220:223]
v_mfma_f32_16x16x32_bf16 v[224:227], v[16:19], v[56:59], v[224:227]
v_mfma_f32_16x16x32_bf16 v[228:231], v[20:23], v[56:59], v[228:231]
v_mfma_f32_16x16x32_bf16 v[232:235], v[24:27], v[56:59], v[232:235]
v_mfma_f32_16x16x32_bf16 v[236:239], v[28:31], v[56:59], v[236:239]
v_mfma_f32_16x16x32_bf16 v[240:243], v[16:19], v[60:63], v[240:243]
v_mfma_f32_16x16x32_bf16 v[244:247], v[20:23], v[60:63], v[244:247]
v_mfma_f32_16x16x32_bf16 v[248:251], v[24:27], v[60:63], v[248:251]
v_mfma_f32_16x16x32_bf16 v[252:255], v[28:31], v[60:63], v[252:255]
s_waitcnt lgkmcnt(0)
s_barrier
v_mfma_f32_16x16x32_bf16 v[128:131], v[64:67], v[80:83], v[128:131]
ds_read_b64_tr_b16 v[16:17], v8 offset:49152
v_mfma_f32_16x16x32_bf16 v[132:135], v[68:71], v[80:83], v[132:135]
ds_read_b64_tr_b16 v[18:19], v8 offset:49664
v_mfma_f32_16x16x32_bf16 v[136:139], v[72:75], v[80:83], v[136:139]
v_mfma_f32_16x16x32_bf16 v[140:143], v[76:79], v[80:83], v[140:143]
ds_read_b128 v[32:35], v4 offset:49152
v_mfma_f32_16x16x32_bf16 v[144:147], v[64:67], v[84:87], v[144:147]
ds_read_b64_tr_b16 v[20:21], v9 offset:49152
v_mfma_f32_16x16x32_bf16 v[148:151], v[68:71], v[84:87], v[148:151]
v_mfma_f32_16x16x32_bf16 v[152:155], v[72:75], v[84:87], v[152:155]
ds_read_b64_tr_b16 v[22:23], v9 offset:49664
v_mfma_f32_16x16x32_bf16 v[156:159], v[76:79], v[84:87], v[156:159]
ds_read_b64_tr_b16 v[24:25], v8 offset:57344
v_mfma_f32_16x16x32_bf16 v[160:163], v[64:67], v[88:91], v[160:163]
v_mfma_f32_16x16x32_bf16 v[164:167], v[68:71], v[88:91], v[164:167]
ds_read_b64_tr_b16 v[26:27], v8 offset:57856
v_mfma_f32_16x16x32_bf16 v[168:171], v[72:75], v[88:91], v[168:171]
ds_read_b64_tr_b16 v[28:29], v9 offset:57344
v_mfma_f32_16x16x32_bf16 v[172:175], v[76:79], v[88:91], v[172:175]
v_mfma_f32_16x16x32_bf16 v[176:179], v[64:67], v[92:95], v[176:179]
ds_read_b64_tr_b16 v[30:31], v9 offset:57856
v_mfma_f32_16x16x32_bf16 v[180:183], v[68:71], v[92:95], v[180:183]
ds_read_b128 v[36:39], v4 offset:51200
v_mfma_f32_16x16x32_bf16 v[184:187], v[72:75], v[92:95], v[184:187]
v_mfma_f32_16x16x32_bf16 v[188:191], v[76:79], v[92:95], v[188:191]
ds_read_b128 v[40:43], v4 offset:53248
v_mfma_f32_16x16x32_bf16 v[192:195], v[64:67], v[96:99], v[192:195]
ds_read_b128 v[44:47], v4 offset:55296
v_mfma_f32_16x16x32_bf16 v[196:199], v[68:71], v[96:99], v[196:199]
v_mfma_f32_16x16x32_bf16 v[200:203], v[72:75], v[96:99], v[200:203]
ds_read_b128 v[48:51], v4 offset:57344
v_mfma_f32_16x16x32_bf16 v[204:207], v[76:79], v[96:99], v[204:207]
ds_read_b128 v[52:55], v4 offset:59392
v_mfma_f32_16x16x32_bf16 v[208:211], v[64:67], v[100:103], v[208:211]
v_mfma_f32_16x16x32_bf16 v[212:215], v[68:71], v[100:103], v[212:215]
ds_read_b128 v[56:59], v4 offset:61440
v_mfma_f32_16x16x32_bf16 v[216:219], v[72:75], v[100:103], v[216:219]
ds_read_b128 v[60:63], v4 offset:63488
v_mfma_f32_16x16x32_bf16 v[220:223], v[76:79], v[100:103], v[220:223]
v_mfma_f32_16x16x32_bf16 v[224:227], v[64:67], v[104:107], v[224:227]
v_mfma_f32_16x16x32_bf16 v[228:231], v[68:71], v[104:107], v[228:231]
v_mfma_f32_16x16x32_bf16 v[232:235], v[72:75], v[104:107], v[232:235]
v_mfma_f32_16x16x32_bf16 v[236:239], v[76:79], v[104:107], v[236:239]
v_mfma_f32_16x16x32_bf16 v[240:243], v[64:67], v[108:111], v[240:243]
v_mfma_f32_16x16x32_bf16 v[244:247], v[68:71], v[108:111], v[244:247]
v_mfma_f32_16x16x32_bf16 v[248:251], v[72:75], v[108:111], v[248:251]
v_mfma_f32_16x16x32_bf16 v[252:255], v[76:79], v[108:111], v[252:255]
s_waitcnt lgkmcnt(0)
v_mfma_f32_16x16x32_bf16 v[128:131], v[16:19], v[32:35], v[128:131]
ds_read_b64_tr_b16 v[64:65], v8 offset:53248
v_mfma_f32_16x16x32_bf16 v[132:135], v[20:23], v[32:35], v[132:135]
ds_read_b64_tr_b16 v[66:67], v8 offset:53760
v_mfma_f32_16x16x32_bf16 v[136:139], v[24:27], v[32:35], v[136:139]
v_mfma_f32_16x16x32_bf16 v[140:143], v[28:31], v[32:35], v[140:143]
ds_read_b128 v[80:83], v5 offset:49152
v_mfma_f32_16x16x32_bf16 v[144:147], v[16:19], v[36:39], v[144:147]
ds_read_b64_tr_b16 v[68:69], v9 offset:53248
v_mfma_f32_16x16x32_bf16 v[148:151], v[20:23], v[36:39], v[148:151]
v_mfma_f32_16x16x32_bf16 v[152:155], v[24:27], v[36:39], v[152:155]
ds_read_b64_tr_b16 v[70:71], v9 offset:53760
v_mfma_f32_16x16x32_bf16 v[156:159], v[28:31], v[36:39], v[156:159]
ds_read_b64_tr_b16 v[72:73], v8 offset:61440
v_mfma_f32_16x16x32_bf16 v[160:163], v[16:19], v[40:43], v[160:163]
v_mfma_f32_16x16x32_bf16 v[164:167], v[20:23], v[40:43], v[164:167]
ds_read_b64_tr_b16 v[74:75], v8 offset:61952
v_mfma_f32_16x16x32_bf16 v[168:171], v[24:27], v[40:43], v[168:171]
ds_read_b64_tr_b16 v[76:77], v9 offset:61440
v_mfma_f32_16x16x32_bf16 v[172:175], v[28:31], v[40:43], v[172:175]
v_mfma_f32_16x16x32_bf16 v[176:179], v[16:19], v[44:47], v[176:179]
ds_read_b64_tr_b16 v[78:79], v9 offset:61952
v_mfma_f32_16x16x32_bf16 v[180:183], v[20:23], v[44:47], v[180:183]
ds_read_b128 v[84:87], v5 offset:51200
v_mfma_f32_16x16x32_bf16 v[184:187], v[24:27], v[44:47], v[184:187]
v_mfma_f32_16x16x32_bf16 v[188:191], v[28:31], v[44:47], v[188:191]
ds_read_b128 v[88:91], v5 offset:53248
v_mfma_f32_16x16x32_bf16 v[192:195], v[16:19], v[48:51], v[192:195]
ds_read_b128 v[92:95], v5 offset:55296
v_mfma_f32_16x16x32_bf16 v[196:199], v[20:23], v[48:51], v[196:199]
v_mfma_f32_16x16x32_bf16 v[200:203], v[24:27], v[48:51], v[200:203]
ds_read_b128 v[96:99], v5 offset:57344
v_mfma_f32_16x16x32_bf16 v[204:207], v[28:31], v[48:51], v[204:207]
ds_read_b128 v[100:103], v5 offset:59392
v_mfma_f32_16x16x32_bf16 v[208:211], v[16:19], v[52:55], v[208:211]
v_mfma_f32_16x16x32_bf16 v[212:215], v[20:23], v[52:55], v[212:215]
ds_read_b128 v[104:107], v5 offset:61440
v_mfma_f32_16x16x32_bf16 v[216:219], v[24:27], v[52:55], v[216:219]
ds_read_b128 v[108:111], v5 offset:63488
v_mfma_f32_16x16x32_bf16 v[220:223], v[28:31], v[52:55], v[220:223]
v_mfma_f32_16x16x32_bf16 v[224:227], v[16:19], v[56:59], v[224:227]
v_mfma_f32_16x16x32_bf16 v[228:231], v[20:23], v[56:59], v[228:231]
v_mfma_f32_16x16x32_bf16 v[232:235], v[24:27], v[56:59], v[232:235]
v_mfma_f32_16x16x32_bf16 v[236:239], v[28:31], v[56:59], v[236:239]
v_mfma_f32_16x16x32_bf16 v[240:243], v[16:19], v[60:63], v[240:243]
v_mfma_f32_16x16x32_bf16 v[244:247], v[20:23], v[60:63], v[244:247]
v_mfma_f32_16x16x32_bf16 v[248:251], v[24:27], v[60:63], v[248:251]
v_mfma_f32_16x16x32_bf16 v[252:255], v[28:31], v[60:63], v[252:255]
s_waitcnt lgkmcnt(0)
s_barrier
v_mfma_f32_16x16x32_bf16 v[128:131], v[64:67], v[80:83], v[128:131]
ds_read_b64_tr_b16 v[16:17], v8 offset:0
v_mfma_f32_16x16x32_bf16 v[132:135], v[68:71], v[80:83], v[132:135]
ds_read_b64_tr_b16 v[18:19], v8 offset:512
v_mfma_f32_16x16x32_bf16 v[136:139], v[72:75], v[80:83], v[136:139]
v_mfma_f32_16x16x32_bf16 v[140:143], v[76:79], v[80:83], v[140:143]
ds_read_b128 v[32:35], v4 offset:0
v_mfma_f32_16x16x32_bf16 v[144:147], v[64:67], v[84:87], v[144:147]
ds_read_b64_tr_b16 v[20:21], v9 offset:0
v_mfma_f32_16x16x32_bf16 v[148:151], v[68:71], v[84:87], v[148:151]
v_mfma_f32_16x16x32_bf16 v[152:155], v[72:75], v[84:87], v[152:155]
ds_read_b64_tr_b16 v[22:23], v9 offset:512
v_mfma_f32_16x16x32_bf16 v[156:159], v[76:79], v[84:87], v[156:159]
ds_read_b64_tr_b16 v[24:25], v8 offset:8192
v_mfma_f32_16x16x32_bf16 v[160:163], v[64:67], v[88:91], v[160:163]
v_mfma_f32_16x16x32_bf16 v[164:167], v[68:71], v[88:91], v[164:167]
ds_read_b64_tr_b16 v[26:27], v8 offset:8704
v_mfma_f32_16x16x32_bf16 v[168:171], v[72:75], v[88:91], v[168:171]
ds_read_b64_tr_b16 v[28:29], v9 offset:8192
v_mfma_f32_16x16x32_bf16 v[172:175], v[76:79], v[88:91], v[172:175]
v_mfma_f32_16x16x32_bf16 v[176:179], v[64:67], v[92:95], v[176:179]
ds_read_b64_tr_b16 v[30:31], v9 offset:8704
v_mfma_f32_16x16x32_bf16 v[180:183], v[68:71], v[92:95], v[180:183]
ds_read_b128 v[36:39], v4 offset:2048
v_mfma_f32_16x16x32_bf16 v[184:187], v[72:75], v[92:95], v[184:187]
v_mfma_f32_16x16x32_bf16 v[188:191], v[76:79], v[92:95], v[188:191]
ds_read_b128 v[40:43], v4 offset:4096
v_mfma_f32_16x16x32_bf16 v[192:195], v[64:67], v[96:99], v[192:195]
ds_read_b128 v[44:47], v4 offset:6144
v_mfma_f32_16x16x32_bf16 v[196:199], v[68:71], v[96:99], v[196:199]
v_mfma_f32_16x16x32_bf16 v[200:203], v[72:75], v[96:99], v[200:203]
ds_read_b128 v[48:51], v4 offset:8192
v_mfma_f32_16x16x32_bf16 v[204:207], v[76:79], v[96:99], v[204:207]
ds_read_b128 v[52:55], v4 offset:10240
v_mfma_f32_16x16x32_bf16 v[208:211], v[64:67], v[100:103], v[208:211]
v_mfma_f32_16x16x32_bf16 v[212:215], v[68:71], v[100:103], v[212:215]
ds_read_b128 v[56:59], v4 offset:12288
v_mfma_f32_16x16x32_bf16 v[216:219], v[72:75], v[100:103], v[216:219]
ds_read_b128 v[60:63], v4 offset:14336
v_mfma_f32_16x16x32_bf16 v[220:223], v[76:79], v[100:103], v[220:223]
v_mfma_f32_16x16x32_bf16 v[224:227], v[64:67], v[104:107], v[224:227]
v_mfma_f32_16x16x32_bf16 v[228:231], v[68:71], v[104:107], v[228:231]
v_mfma_f32_16x16x32_bf16 v[232:235], v[72:75], v[104:107], v[232:235]
v_mfma_f32_16x16x32_bf16 v[236:239], v[76:79], v[104:107], v[236:239]
v_mfma_f32_16x16x32_bf16 v[240:243], v[64:67], v[108:111], v[240:243]
v_mfma_f32_16x16x32_bf16 v[244:247], v[68:71], v[108:111], v[244:247]
v_mfma_f32_16x16x32_bf16 v[248:251], v[72:75], v[108:111], v[248:251]
v_mfma_f32_16x16x32_bf16 v[252:255], v[76:79], v[108:111], v[252:255]
s_waitcnt lgkmcnt(0)
v_mfma_f32_16x16x32_bf16 v[128:131], v[16:19], v[32:35], v[128:131]
ds_read_b64_tr_b16 v[64:65], v8 offset:4096
v_mfma_f32_16x16x32_bf16 v[132:135], v[20:23], v[32:35], v[132:135]
ds_read_b64_tr_b16 v[66:67], v8 offset:4608
v_mfma_f32_16x16x32_bf16 v[136:139], v[24:27], v[32:35], v[136:139]
v_mfma_f32_16x16x32_bf16 v[140:143], v[28:31], v[32:35], v[140:143]
ds_read_b128 v[80:83], v5 offset:0
v_mfma_f32_16x16x32_bf16 v[144:147], v[16:19], v[36:39], v[144:147]
ds_read_b64_tr_b16 v[68:69], v9 offset:4096
v_mfma_f32_16x16x32_bf16 v[148:151], v[20:23], v[36:39], v[148:151]
v_mfma_f32_16x16x32_bf16 v[152:155], v[24:27], v[36:39], v[152:155]
ds_read_b64_tr_b16 v[70:71], v9 offset:4608
v_mfma_f32_16x16x32_bf16 v[156:159], v[28:31], v[36:39], v[156:159]
ds_read_b64_tr_b16 v[72:73], v8 offset:12288
v_mfma_f32_16x16x32_bf16 v[160:163], v[16:19], v[40:43], v[160:163]
v_mfma_f32_16x16x32_bf16 v[164:167], v[20:23], v[40:43], v[164:167]
ds_read_b64_tr_b16 v[74:75], v8 offset:12800
v_mfma_f32_16x16x32_bf16 v[168:171], v[24:27], v[40:43], v[168:171]
ds_read_b64_tr_b16 v[76:77], v9 offset:12288
v_mfma_f32_16x16x32_bf16 v[172:175], v[28:31], v[40:43], v[172:175]
v_mfma_f32_16x16x32_bf16 v[176:179], v[16:19], v[44:47], v[176:179]
ds_read_b64_tr_b16 v[78:79], v9 offset:12800
v_mfma_f32_16x16x32_bf16 v[180:183], v[20:23], v[44:47], v[180:183]
ds_read_b128 v[84:87], v5 offset:2048
v_mfma_f32_16x16x32_bf16 v[184:187], v[24:27], v[44:47], v[184:187]
v_mfma_f32_16x16x32_bf16 v[188:191], v[28:31], v[44:47], v[188:191]
ds_read_b128 v[88:91], v5 offset:4096
v_mfma_f32_16x16x32_bf16 v[192:195], v[16:19], v[48:51], v[192:195]
ds_read_b128 v[92:95], v5 offset:6144
v_mfma_f32_16x16x32_bf16 v[196:199], v[20:23], v[48:51], v[196:199]
v_mfma_f32_16x16x32_bf16 v[200:203], v[24:27], v[48:51], v[200:203]
ds_read_b128 v[96:99], v5 offset:8192
v_mfma_f32_16x16x32_bf16 v[204:207], v[28:31], v[48:51], v[204:207]
ds_read_b128 v[100:103], v5 offset:10240
v_mfma_f32_16x16x32_bf16 v[208:211], v[16:19], v[52:55], v[208:211]
v_mfma_f32_16x16x32_bf16 v[212:215], v[20:23], v[52:55], v[212:215]
ds_read_b128 v[104:107], v5 offset:12288
v_mfma_f32_16x16x32_bf16 v[216:219], v[24:27], v[52:55], v[216:219]
ds_read_b128 v[108:111], v5 offset:14336
v_mfma_f32_16x16x32_bf16 v[220:223], v[28:31], v[52:55], v[220:223]
v_mfma_f32_16x16x32_bf16 v[224:227], v[16:19], v[56:59], v[224:227]
v_mfma_f32_16x16x32_bf16 v[228:231], v[20:23], v[56:59], v[228:231]
v_mfma_f32_16x16x32_bf16 v[232:235], v[24:27], v[56:59], v[232:235]
v_mfma_f32_16x16x32_bf16 v[236:239], v[28:31], v[56:59], v[236:239]
v_mfma_f32_16x16x32_bf16 v[240:243], v[16:19], v[60:63], v[240:243]
v_mfma_f32_16x16x32_bf16 v[244:247], v[20:23], v[60:63], v[244:247]
v_mfma_f32_16x16x32_bf16 v[248:251], v[24:27], v[60:63], v[248:251]
v_mfma_f32_16x16x32_bf16 v[252:255], v[28:31], v[60:63], v[252:255]
s_waitcnt lgkmcnt(0)
s_barrier
v_mfma_f32_16x16x32_bf16 v[128:131], v[64:67], v[80:83], v[128:131]
ds_read_b64_tr_b16 v[16:17], v10 offset:0
v_mfma_f32_16x16x32_bf16 v[132:135], v[68:71], v[80:83], v[132:135]
ds_read_b64_tr_b16 v[18:19], v10 offset:512
v_mfma_f32_16x16x32_bf16 v[136:139], v[72:75], v[80:83], v[136:139]
v_mfma_f32_16x16x32_bf16 v[140:143], v[76:79], v[80:83], v[140:143]
ds_read_b128 v[32:35], v6 offset:0
v_mfma_f32_16x16x32_bf16 v[144:147], v[64:67], v[84:87], v[144:147]
ds_read_b64_tr_b16 v[20:21], v11 offset:0
v_mfma_f32_16x16x32_bf16 v[148:151], v[68:71], v[84:87], v[148:151]
v_mfma_f32_16x16x32_bf16 v[152:155], v[72:75], v[84:87], v[152:155]
ds_read_b64_tr_b16 v[22:23], v11 offset:512
v_mfma_f32_16x16x32_bf16 v[156:159], v[76:79], v[84:87], v[156:159]
ds_read_b64_tr_b16 v[24:25], v10 offset:8192
v_mfma_f32_16x16x32_bf16 v[160:163], v[64:67], v[88:91], v[160:163]
v_mfma_f32_16x16x32_bf16 v[164:167], v[68:71], v[88:91], v[164:167]
ds_read_b64_tr_b16 v[26:27], v10 offset:8704
v_mfma_f32_16x16x32_bf16 v[168:171], v[72:75], v[88:91], v[168:171]
ds_read_b64_tr_b16 v[28:29], v11 offset:8192
v_mfma_f32_16x16x32_bf16 v[172:175], v[76:79], v[88:91], v[172:175]
v_mfma_f32_16x16x32_bf16 v[176:179], v[64:67], v[92:95], v[176:179]
ds_read_b64_tr_b16 v[30:31], v11 offset:8704
v_mfma_f32_16x16x32_bf16 v[180:183], v[68:71], v[92:95], v[180:183]
ds_read_b128 v[36:39], v6 offset:2048
v_mfma_f32_16x16x32_bf16 v[184:187], v[72:75], v[92:95], v[184:187]
v_mfma_f32_16x16x32_bf16 v[188:191], v[76:79], v[92:95], v[188:191]
ds_read_b128 v[40:43], v6 offset:4096
v_mfma_f32_16x16x32_bf16 v[192:195], v[64:67], v[96:99], v[192:195]
ds_read_b128 v[44:47], v6 offset:6144
v_mfma_f32_16x16x32_bf16 v[196:199], v[68:71], v[96:99], v[196:199]
v_mfma_f32_16x16x32_bf16 v[200:203], v[72:75], v[96:99], v[200:203]
ds_read_b128 v[48:51], v6 offset:8192
v_mfma_f32_16x16x32_bf16 v[204:207], v[76:79], v[96:99], v[204:207]
ds_read_b128 v[52:55], v6 offset:10240
v_mfma_f32_16x16x32_bf16 v[208:211], v[64:67], v[100:103], v[208:211]
v_mfma_f32_16x16x32_bf16 v[212:215], v[68:71], v[100:103], v[212:215]
ds_read_b128 v[56:59], v6 offset:12288
v_mfma_f32_16x16x32_bf16 v[216:219], v[72:75], v[100:103], v[216:219]
ds_read_b128 v[60:63], v6 offset:14336
v_mfma_f32_16x16x32_bf16 v[220:223], v[76:79], v[100:103], v[220:223]
v_mfma_f32_16x16x32_bf16 v[224:227], v[64:67], v[104:107], v[224:227]
v_mfma_f32_16x16x32_bf16 v[228:231], v[68:71], v[104:107], v[228:231]
v_mfma_f32_16x16x32_bf16 v[232:235], v[72:75], v[104:107], v[232:235]
v_mfma_f32_16x16x32_bf16 v[236:239], v[76:79], v[104:107], v[236:239]
v_mfma_f32_16x16x32_bf16 v[240:243], v[64:67], v[108:111], v[240:243]
v_mfma_f32_16x16x32_bf16 v[244:247], v[68:71], v[108:111], v[244:247]
v_mfma_f32_16x16x32_bf16 v[248:251], v[72:75], v[108:111], v[248:251]
v_mfma_f32_16x16x32_bf16 v[252:255], v[76:79], v[108:111], v[252:255]
s_waitcnt lgkmcnt(0)
v_mfma_f32_16x16x32_bf16 v[128:131], v[16:19], v[32:35], v[128:131]
ds_read_b64_tr_b16 v[64:65], v10 offset:4096
v_mfma_f32_16x16x32_bf16 v[132:135], v[20:23], v[32:35], v[132:135]
ds_read_b64_tr_b16 v[66:67], v10 offset:4608
v_mfma_f32_16x16x32_bf16 v[136:139], v[24:27], v[32:35], v[136:139]
v_mfma_f32_16x16x32_bf16 v[140:143], v[28:31], v[32:35], v[140:143]
ds_read_b128 v[80:83], v7 offset:0
v_mfma_f32_16x16x32_bf16 v[144:147], v[16:19], v[36:39], v[144:147]
ds_read_b64_tr_b16 v[68:69], v11 offset:4096
v_mfma_f32_16x16x32_bf16 v[148:151], v[20:23], v[36:39], v[148:151]
v_mfma_f32_16x16x32_bf16 v[152:155], v[24:27], v[36:39], v[152:155]
ds_read_b64_tr_b16 v[70:71], v11 offset:4608
v_mfma_f32_16x16x32_bf16 v[156:159], v[28:31], v[36:39], v[156:159]
ds_read_b64_tr_b16 v[72:73], v10 offset:12288
v_mfma_f32_16x16x32_bf16 v[160:163], v[16:19], v[40:43], v[160:163]
v_mfma_f32_16x16x32_bf16 v[164:167], v[20:23], v[40:43], v[164:167]
ds_read_b64_tr_b16 v[74:75], v10 offset:12800
v_mfma_f32_16x16x32_bf16 v[168:171], v[24:27], v[40:43], v[168:171]
ds_read_b64_tr_b16 v[76:77], v11 offset:12288
v_mfma_f32_16x16x32_bf16 v[172:175], v[28:31], v[40:43], v[172:175]
v_mfma_f32_16x16x32_bf16 v[176:179], v[16:19], v[44:47], v[176:179]
ds_read_b64_tr_b16 v[78:79], v11 offset:12800
v_mfma_f32_16x16x32_bf16 v[180:183], v[20:23], v[44:47], v[180:183]
ds_read_b128 v[84:87], v7 offset:2048
v_mfma_f32_16x16x32_bf16 v[184:187], v[24:27], v[44:47], v[184:187]
v_mfma_f32_16x16x32_bf16 v[188:191], v[28:31], v[44:47], v[188:191]
ds_read_b128 v[88:91], v7 offset:4096
v_mfma_f32_16x16x32_bf16 v[192:195], v[16:19], v[48:51], v[192:195]
ds_read_b128 v[92:95], v7 offset:6144
v_mfma_f32_16x16x32_bf16 v[196:199], v[20:23], v[48:51], v[196:199]
v_mfma_f32_16x16x32_bf16 v[200:203], v[24:27], v[48:51], v[200:203]
ds_read_b128 v[96:99], v7 offset:8192
v_mfma_f32_16x16x32_bf16 v[204:207], v[28:31], v[48:51], v[204:207]
ds_read_b128 v[100:103], v7 offset:10240
v_mfma_f32_16x16x32_bf16 v[208:211], v[16:19], v[52:55], v[208:211]
v_mfma_f32_16x16x32_bf16 v[212:215], v[20:23], v[52:55], v[212:215]
ds_read_b128 v[104:107], v7 offset:12288
v_mfma_f32_16x16x32_bf16 v[216:219], v[24:27], v[52:55], v[216:219]
ds_read_b128 v[108:111], v7 offset:14336
v_mfma_f32_16x16x32_bf16 v[220:223], v[28:31], v[52:55], v[220:223]
v_mfma_f32_16x16x32_bf16 v[224:227], v[16:19], v[56:59], v[224:227]
v_mfma_f32_16x16x32_bf16 v[228:231], v[20:23], v[56:59], v[228:231]
v_mfma_f32_16x16x32_bf16 v[232:235], v[24:27], v[56:59], v[232:235]
v_mfma_f32_16x16x32_bf16 v[236:239], v[28:31], v[56:59], v[236:239]
v_mfma_f32_16x16x32_bf16 v[240:243], v[16:19], v[60:63], v[240:243]
v_mfma_f32_16x16x32_bf16 v[244:247], v[20:23], v[60:63], v[244:247]
v_mfma_f32_16x16x32_bf16 v[248:251], v[24:27], v[60:63], v[248:251]
v_mfma_f32_16x16x32_bf16 v[252:255], v[28:31], v[60:63], v[252:255]
s_waitcnt lgkmcnt(0)
s_barrier
v_mfma_f32_16x16x32_bf16 v[128:131], v[64:67], v[80:83], v[128:131]
ds_read_b64_tr_b16 v[16:17], v8 offset:49152
v_mfma_f32_16x16x32_bf16 v[132:135], v[68:71], v[80:83], v[132:135]
ds_read_b64_tr_b16 v[18:19], v8 offset:49664
v_mfma_f32_16x16x32_bf16 v[136:139], v[72:75], v[80:83], v[136:139]
v_mfma_f32_16x16x32_bf16 v[140:143], v[76:79], v[80:83], v[140:143]
ds_read_b128 v[32:35], v4 offset:49152
v_mfma_f32_16x16x32_bf16 v[144:147], v[64:67], v[84:87], v[144:147]
ds_read_b64_tr_b16 v[20:21], v9 offset:49152
v_mfma_f32_16x16x32_bf16 v[148:151], v[68:71], v[84:87], v[148:151]
v_mfma_f32_16x16x32_bf16 v[152:155], v[72:75], v[84:87], v[152:155]
ds_read_b64_tr_b16 v[22:23], v9 offset:49664
v_mfma_f32_16x16x32_bf16 v[156:159], v[76:79], v[84:87], v[156:159]
ds_read_b64_tr_b16 v[24:25], v8 offset:57344
v_mfma_f32_16x16x32_bf16 v[160:163], v[64:67], v[88:91], v[160:163]
v_mfma_f32_16x16x32_bf16 v[164:167], v[68:71], v[88:91], v[164:167]
ds_read_b64_tr_b16 v[26:27], v8 offset:57856
v_mfma_f32_16x16x32_bf16 v[168:171], v[72:75], v[88:91], v[168:171]
ds_read_b64_tr_b16 v[28:29], v9 offset:57344
v_mfma_f32_16x16x32_bf16 v[172:175], v[76:79], v[88:91], v[172:175]
v_mfma_f32_16x16x32_bf16 v[176:179], v[64:67], v[92:95], v[176:179]
ds_read_b64_tr_b16 v[30:31], v9 offset:57856
v_mfma_f32_16x16x32_bf16 v[180:183], v[68:71], v[92:95], v[180:183]
ds_read_b128 v[36:39], v4 offset:51200
v_mfma_f32_16x16x32_bf16 v[184:187], v[72:75], v[92:95], v[184:187]
v_mfma_f32_16x16x32_bf16 v[188:191], v[76:79], v[92:95], v[188:191]
ds_read_b128 v[40:43], v4 offset:53248
v_mfma_f32_16x16x32_bf16 v[192:195], v[64:67], v[96:99], v[192:195]
ds_read_b128 v[44:47], v4 offset:55296
v_mfma_f32_16x16x32_bf16 v[196:199], v[68:71], v[96:99], v[196:199]
v_mfma_f32_16x16x32_bf16 v[200:203], v[72:75], v[96:99], v[200:203]
ds_read_b128 v[48:51], v4 offset:57344
v_mfma_f32_16x16x32_bf16 v[204:207], v[76:79], v[96:99], v[204:207]
ds_read_b128 v[52:55], v4 offset:59392
v_mfma_f32_16x16x32_bf16 v[208:211], v[64:67], v[100:103], v[208:211]
v_mfma_f32_16x16x32_bf16 v[212:215], v[68:71], v[100:103], v[212:215]
ds_read_b128 v[56:59], v4 offset:61440
v_mfma_f32_16x16x32_bf16 v[216:219], v[72:75], v[100:103], v[216:219]
ds_read_b128 v[60:63], v4 offset:63488
v_mfma_f32_16x16x32_bf16 v[220:223], v[76:79], v[100:103], v[220:223]
v_mfma_f32_16x16x32_bf16 v[224:227], v[64:67], v[104:107], v[224:227]
v_mfma_f32_16x16x32_bf16 v[228:231], v[68:71], v[104:107], v[228:231]
v_mfma_f32_16x16x32_bf16 v[232:235], v[72:75], v[104:107], v[232:235]
v_mfma_f32_16x16x32_bf16 v[236:239], v[76:79], v[104:107], v[236:239]
v_mfma_f32_16x16x32_bf16 v[240:243], v[64:67], v[108:111], v[240:243]
v_mfma_f32_16x16x32_bf16 v[244:247], v[68:71], v[108:111], v[244:247]
v_mfma_f32_16x16x32_bf16 v[248:251], v[72:75], v[108:111], v[248:251]
v_mfma_f32_16x16x32_bf16 v[252:255], v[76:79], v[108:111], v[252:255]
s_waitcnt lgkmcnt(0)
v_mfma_f32_16x16x32_bf16 v[128:131], v[16:19], v[32:35], v[128:131]
ds_read_b64_tr_b16 v[64:65], v8 offset:53248
v_mfma_f32_16x16x32_bf16 v[132:135], v[20:23], v[32:35], v[132:135]
ds_read_b64_tr_b16 v[66:67], v8 offset:53760
v_mfma_f32_16x16x32_bf16 v[136:139], v[24:27], v[32:35], v[136:139]
v_mfma_f32_16x16x32_bf16 v[140:143], v[28:31], v[32:35], v[140:143]
ds_read_b128 v[80:83], v5 offset:49152
v_mfma_f32_16x16x32_bf16 v[144:147], v[16:19], v[36:39], v[144:147]
ds_read_b64_tr_b16 v[68:69], v9 offset:53248
v_mfma_f32_16x16x32_bf16 v[148:151], v[20:23], v[36:39], v[148:151]
v_mfma_f32_16x16x32_bf16 v[152:155], v[24:27], v[36:39], v[152:155]
ds_read_b64_tr_b16 v[70:71], v9 offset:53760
v_mfma_f32_16x16x32_bf16 v[156:159], v[28:31], v[36:39], v[156:159]
ds_read_b64_tr_b16 v[72:73], v8 offset:61440
v_mfma_f32_16x16x32_bf16 v[160:163], v[16:19], v[40:43], v[160:163]
v_mfma_f32_16x16x32_bf16 v[164:167], v[20:23], v[40:43], v[164:167]
ds_read_b64_tr_b16 v[74:75], v8 offset:61952
v_mfma_f32_16x16x32_bf16 v[168:171], v[24:27], v[40:43], v[168:171]
ds_read_b64_tr_b16 v[76:77], v9 offset:61440
v_mfma_f32_16x16x32_bf16 v[172:175], v[28:31], v[40:43], v[172:175]
v_mfma_f32_16x16x32_bf16 v[176:179], v[16:19], v[44:47], v[176:179]
ds_read_b64_tr_b16 v[78:79], v9 offset:61952
v_mfma_f32_16x16x32_bf16 v[180:183], v[20:23], v[44:47], v[180:183]
ds_read_b128 v[84:87], v5 offset:51200
v_mfma_f32_16x16x32_bf16 v[184:187], v[24:27], v[44:47], v[184:187]
v_mfma_f32_16x16x32_bf16 v[188:191], v[28:31], v[44:47], v[188:191]
ds_read_b128 v[88:91], v5 offset:53248
v_mfma_f32_16x16x32_bf16 v[192:195], v[16:19], v[48:51], v[192:195]
ds_read_b128 v[92:95], v5 offset:55296
v_mfma_f32_16x16x32_bf16 v[196:199], v[20:23], v[48:51], v[196:199]
v_mfma_f32_16x16x32_bf16 v[200:203], v[24:27], v[48:51], v[200:203]
ds_read_b128 v[96:99], v5 offset:57344
v_mfma_f32_16x16x32_bf16 v[204:207], v[28:31], v[48:51], v[204:207]
ds_read_b128 v[100:103], v5 offset:59392
v_mfma_f32_16x16x32_bf16 v[208:211], v[16:19], v[52:55], v[208:211]
v_mfma_f32_16x16x32_bf16 v[212:215], v[20:23], v[52:55], v[212:215]
ds_read_b128 v[104:107], v5 offset:61440
v_mfma_f32_16x16x32_bf16 v[216:219], v[24:27], v[52:55], v[216:219]
ds_read_b128 v[108:111], v5 offset:63488
v_mfma_f32_16x16x32_bf16 v[220:223], v[28:31], v[52:55], v[220:223]
v_mfma_f32_16x16x32_bf16 v[224:227], v[16:19], v[56:59], v[224:227]
v_mfma_f32_16x16x32_bf16 v[228:231], v[20:23], v[56:59], v[228:231]
v_mfma_f32_16x16x32_bf16 v[232:235], v[24:27], v[56:59], v[232:235]
v_mfma_f32_16x16x32_bf16 v[236:239], v[28:31], v[56:59], v[236:239]
v_mfma_f32_16x16x32_bf16 v[240:243], v[16:19], v[60:63], v[240:243]
v_mfma_f32_16x16x32_bf16 v[244:247], v[20:23], v[60:63], v[244:247]
v_mfma_f32_16x16x32_bf16 v[248:251], v[24:27], v[60:63], v[248:251]
v_mfma_f32_16x16x32_bf16 v[252:255], v[28:31], v[60:63], v[252:255]
s_waitcnt lgkmcnt(0)
s_barrier
v_mfma_f32_16x16x32_bf16 v[128:131], v[64:67], v[80:83], v[128:131]
ds_read_b64_tr_b16 v[16:17], v8 offset:0
v_mfma_f32_16x16x32_bf16 v[132:135], v[68:71], v[80:83], v[132:135]
ds_read_b64_tr_b16 v[18:19], v8 offset:512
v_mfma_f32_16x16x32_bf16 v[136:139], v[72:75], v[80:83], v[136:139]
v_mfma_f32_16x16x32_bf16 v[140:143], v[76:79], v[80:83], v[140:143]
ds_read_b128 v[32:35], v4 offset:0
v_mfma_f32_16x16x32_bf16 v[144:147], v[64:67], v[84:87], v[144:147]
ds_read_b64_tr_b16 v[20:21], v9 offset:0
v_mfma_f32_16x16x32_bf16 v[148:151], v[68:71], v[84:87], v[148:151]
v_mfma_f32_16x16x32_bf16 v[152:155], v[72:75], v[84:87], v[152:155]
ds_read_b64_tr_b16 v[22:23], v9 offset:512
v_mfma_f32_16x16x32_bf16 v[156:159], v[76:79], v[84:87], v[156:159]
ds_read_b64_tr_b16 v[24:25], v8 offset:8192
v_mfma_f32_16x16x32_bf16 v[160:163], v[64:67], v[88:91], v[160:163]
v_mfma_f32_16x16x32_bf16 v[164:167], v[68:71], v[88:91], v[164:167]
ds_read_b64_tr_b16 v[26:27], v8 offset:8704
v_mfma_f32_16x16x32_bf16 v[168:171], v[72:75], v[88:91], v[168:171]
ds_read_b64_tr_b16 v[28:29], v9 offset:8192
v_mfma_f32_16x16x32_bf16 v[172:175], v[76:79], v[88:91], v[172:175]
v_mfma_f32_16x16x32_bf16 v[176:179], v[64:67], v[92:95], v[176:179]
ds_read_b64_tr_b16 v[30:31], v9 offset:8704
v_mfma_f32_16x16x32_bf16 v[180:183], v[68:71], v[92:95], v[180:183]
ds_read_b128 v[36:39], v4 offset:2048
v_mfma_f32_16x16x32_bf16 v[184:187], v[72:75], v[92:95], v[184:187]
v_mfma_f32_16x16x32_bf16 v[188:191], v[76:79], v[92:95], v[188:191]
ds_read_b128 v[40:43], v4 offset:4096
v_mfma_f32_16x16x32_bf16 v[192:195], v[64:67], v[96:99], v[192:195]
ds_read_b128 v[44:47], v4 offset:6144
v_mfma_f32_16x16x32_bf16 v[196:199], v[68:71], v[96:99], v[196:199]
v_mfma_f32_16x16x32_bf16 v[200:203], v[72:75], v[96:99], v[200:203]
ds_read_b128 v[48:51], v4 offset:8192
v_mfma_f32_16x16x32_bf16 v[204:207], v[76:79], v[96:99], v[204:207]
ds_read_b128 v[52:55], v4 offset:10240
v_mfma_f32_16x16x32_bf16 v[208:211], v[64:67], v[100:103], v[208:211]
v_mfma_f32_16x16x32_bf16 v[212:215], v[68:71], v[100:103], v[212:215]
ds_read_b128 v[56:59], v4 offset:12288
v_mfma_f32_16x16x32_bf16 v[216:219], v[72:75], v[100:103], v[216:219]
ds_read_b128 v[60:63], v4 offset:14336
v_mfma_f32_16x16x32_bf16 v[220:223], v[76:79], v[100:103], v[220:223]
v_mfma_f32_16x16x32_bf16 v[224:227], v[64:67], v[104:107], v[224:227]
v_mfma_f32_16x16x32_bf16 v[228:231], v[68:71], v[104:107], v[228:231]
v_mfma_f32_16x16x32_bf16 v[232:235], v[72:75], v[104:107], v[232:235]
v_mfma_f32_16x16x32_bf16 v[236:239], v[76:79], v[104:107], v[236:239]
v_mfma_f32_16x16x32_bf16 v[240:243], v[64:67], v[108:111], v[240:243]
v_mfma_f32_16x16x32_bf16 v[244:247], v[68:71], v[108:111], v[244:247]
v_mfma_f32_16x16x32_bf16 v[248:251], v[72:75], v[108:111], v[248:251]
v_mfma_f32_16x16x32_bf16 v[252:255], v[76:79], v[108:111], v[252:255]
s_waitcnt lgkmcnt(0)
v_mfma_f32_16x16x32_bf16 v[128:131], v[16:19], v[32:35], v[128:131]
ds_read_b64_tr_b16 v[64:65], v8 offset:4096
v_mfma_f32_16x16x32_bf16 v[132:135], v[20:23], v[32:35], v[132:135]
ds_read_b64_tr_b16 v[66:67], v8 offset:4608
v_mfma_f32_16x16x32_bf16 v[136:139], v[24:27], v[32:35], v[136:139]
v_mfma_f32_16x16x32_bf16 v[140:143], v[28:31], v[32:35], v[140:143]
ds_read_b128 v[80:83], v5 offset:0
v_mfma_f32_16x16x32_bf16 v[144:147], v[16:19], v[36:39], v[144:147]
ds_read_b64_tr_b16 v[68:69], v9 offset:4096
v_mfma_f32_16x16x32_bf16 v[148:151], v[20:23], v[36:39], v[148:151]
v_mfma_f32_16x16x32_bf16 v[152:155], v[24:27], v[36:39], v[152:155]
ds_read_b64_tr_b16 v[70:71], v9 offset:4608
v_mfma_f32_16x16x32_bf16 v[156:159], v[28:31], v[36:39], v[156:159]
ds_read_b64_tr_b16 v[72:73], v8 offset:12288
v_mfma_f32_16x16x32_bf16 v[160:163], v[16:19], v[40:43], v[160:163]
v_mfma_f32_16x16x32_bf16 v[164:167], v[20:23], v[40:43], v[164:167]
ds_read_b64_tr_b16 v[74:75], v8 offset:12800
v_mfma_f32_16x16x32_bf16 v[168:171], v[24:27], v[40:43], v[168:171]
ds_read_b64_tr_b16 v[76:77], v9 offset:12288
v_mfma_f32_16x16x32_bf16 v[172:175], v[28:31], v[40:43], v[172:175]
v_mfma_f32_16x16x32_bf16 v[176:179], v[16:19], v[44:47], v[176:179]
ds_read_b64_tr_b16 v[78:79], v9 offset:12800
v_mfma_f32_16x16x32_bf16 v[180:183], v[20:23], v[44:47], v[180:183]
ds_read_b128 v[84:87], v5 offset:2048
v_mfma_f32_16x16x32_bf16 v[184:187], v[24:27], v[44:47], v[184:187]
v_mfma_f32_16x16x32_bf16 v[188:191], v[28:31], v[44:47], v[188:191]
ds_read_b128 v[88:91], v5 offset:4096
v_mfma_f32_16x16x32_bf16 v[192:195], v[16:19], v[48:51], v[192:195]
ds_read_b128 v[92:95], v5 offset:6144
v_mfma_f32_16x16x32_bf16 v[196:199], v[20:23], v[48:51], v[196:199]
v_mfma_f32_16x16x32_bf16 v[200:203], v[24:27], v[48:51], v[200:203]
ds_read_b128 v[96:99], v5 offset:8192
v_mfma_f32_16x16x32_bf16 v[204:207], v[28:31], v[48:51], v[204:207]
ds_read_b128 v[100:103], v5 offset:10240
v_mfma_f32_16x16x32_bf16 v[208:211], v[16:19], v[52:55], v[208:211]
v_mfma_f32_16x16x32_bf16 v[212:215], v[20:23], v[52:55], v[212:215]
ds_read_b128 v[104:107], v5 offset:12288
v_mfma_f32_16x16x32_bf16 v[216:219], v[24:27], v[52:55], v[216:219]
ds_read_b128 v[108:111], v5 offset:14336
v_mfma_f32_16x16x32_bf16 v[220:223], v[28:31], v[52:55], v[220:223]
v_mfma_f32_16x16x32_bf16 v[224:227], v[16:19], v[56:59], v[224:227]
v_mfma_f32_16x16x32_bf16 v[228:231], v[20:23], v[56:59], v[228:231]
v_mfma_f32_16x16x32_bf16 v[232:235], v[24:27], v[56:59], v[232:235]
v_mfma_f32_16x16x32_bf16 v[236:239], v[28:31], v[56:59], v[236:239]
v_mfma_f32_16x16x32_bf16 v[240:243], v[16:19], v[60:63], v[240:243]
v_mfma_f32_16x16x32_bf16 v[244:247], v[20:23], v[60:63], v[244:247]
v_mfma_f32_16x16x32_bf16 v[248:251], v[24:27], v[60:63], v[248:251]
v_mfma_f32_16x16x32_bf16 v[252:255], v[28:31], v[60:63], v[252:255]
s_waitcnt lgkmcnt(0)
s_barrier
v_mfma_f32_16x16x32_bf16 v[128:131], v[64:67], v[80:83], v[128:131]
s_lshl_b32 s100, s81, 7
v_lshlrev_b32 v13, 4, v3
v_mfma_f32_16x16x32_bf16 v[132:135], v[68:71], v[80:83], v[132:135]
s_add_u32 s100, s100, 163328
v_add_u32 v13, s100, v13
v_mfma_f32_16x16x32_bf16 v[136:139], v[72:75], v[80:83], v[136:139]
s_mul_i32 s100, s80, 87552
s_mul_i32 s101, s80, 64000
v_mfma_f32_16x16x32_bf16 v[140:143], v[76:79], v[80:83], v[140:143]
s_add_u32 s100, s100, 72192
s_add_u32 s101, s101, 96768
v_mfma_f32_16x16x32_bf16 v[144:147], v[64:67], v[84:87], v[144:147]
v_lshl_add_u32 v14, v2, 4, s100
v_mfma_f32_16x16x32_bf16 v[148:151], v[68:71], v[84:87], v[148:151]
v_lshl_add_u32 v12, v2, 4, s101
v_mfma_f32_16x16x32_bf16 v[152:155], v[72:75], v[84:87], v[152:155]
ds_read_b128 v[32:35], v14 offset:0
v_mfma_f32_16x16x32_bf16 v[156:159], v[76:79], v[84:87], v[156:159]
ds_read_b128 v[36:39], v14 offset:256
v_mfma_f32_16x16x32_bf16 v[160:163], v[64:67], v[88:91], v[160:163]
ds_read_b128 v[40:43], v14 offset:512
v_mfma_f32_16x16x32_bf16 v[164:167], v[68:71], v[88:91], v[164:167]
ds_read_b128 v[44:47], v14 offset:768
v_mfma_f32_16x16x32_bf16 v[168:171], v[72:75], v[88:91], v[168:171]
ds_read_b128 v[48:51], v12 offset:0
v_mfma_f32_16x16x32_bf16 v[172:175], v[76:79], v[88:91], v[172:175]
ds_read_b128 v[52:55], v12 offset:256
v_mfma_f32_16x16x32_bf16 v[176:179], v[64:67], v[92:95], v[176:179]
ds_read_b128 v[56:59], v12 offset:512
v_mfma_f32_16x16x32_bf16 v[180:183], v[68:71], v[92:95], v[180:183]
ds_read_b128 v[60:63], v12 offset:768
v_mfma_f32_16x16x32_bf16 v[184:187], v[72:75], v[92:95], v[184:187]
ds_read_b128 v[16:19], v13 offset:0
v_mfma_f32_16x16x32_bf16 v[188:191], v[76:79], v[92:95], v[188:191]
ds_read_b128 v[20:23], v13 offset:64
v_mfma_f32_16x16x32_bf16 v[192:195], v[64:67], v[96:99], v[192:195]
ds_read_b128 v[24:27], v13 offset:256
v_mfma_f32_16x16x32_bf16 v[196:199], v[68:71], v[96:99], v[196:199]
ds_read_b128 v[28:31], v13 offset:320
s_lshl_b32 s100, s34, 8
v_mfma_f32_16x16x32_bf16 v[200:203], v[72:75], v[96:99], v[200:203]
s_lshl_b32 s101, s80, 7
s_add_u32 s100, s100, s101
v_mfma_f32_16x16x32_bf16 v[204:207], v[76:79], v[96:99], v[204:207]
s_lshr_b32 s74, s100, 4
s_mul_i32 s74, s74, 54
v_mfma_f32_16x16x32_bf16 v[208:211], v[64:67], v[100:103], v[208:211]
s_lshl_b32 s101, s35, 1
s_add_u32 s101, s101, s81
v_mfma_f32_16x16x32_bf16 v[212:215], v[68:71], v[100:103], v[212:215]
s_add_u32 s74, s74, s101
s_lshl_b32 s74, s74, 10
v_mfma_f32_16x16x32_bf16 v[216:219], v[72:75], v[100:103], v[216:219]
s_add_u32 s74, s74, 10485760
s_lshr_b32 s100, s100, 7
v_mfma_f32_16x16x32_bf16 v[220:223], v[76:79], v[100:103], v[220:223]
s_lshl_b32 s100, s100, 14
s_lshl_b32 s101, s101, 8
v_mfma_f32_16x16x32_bf16 v[224:227], v[64:67], v[104:107], v[224:227]
s_add_u32 s100, s100, s101
s_add_u32 s93, s100, 17661952
v_mfma_f32_16x16x32_bf16 v[228:231], v[68:71], v[104:107], v[228:231]
v_mfma_f32_16x16x32_bf16 v[232:235], v[72:75], v[104:107], v[232:235]
v_mfma_f32_16x16x32_bf16 v[236:239], v[76:79], v[104:107], v[236:239]
v_mfma_f32_16x16x32_bf16 v[240:243], v[64:67], v[108:111], v[240:243]
v_mfma_f32_16x16x32_bf16 v[244:247], v[68:71], v[108:111], v[244:247]
v_mfma_f32_16x16x32_bf16 v[248:251], v[72:75], v[108:111], v[248:251]
v_mfma_f32_16x16x32_bf16 v[252:255], v[76:79], v[108:111], v[252:255]
s_setprio 2
s_mov_b32 s96, 0xc0135761
s_mov_b32 s97, 0xbdd2d3e8
s_waitcnt lgkmcnt(0)

v_pk_fma_f32 v[128:129], v[16:17], v[32:33], v[128:129] op_sel_hi:[1,0,1]
v_pk_fma_f32 v[130:131], v[18:19], v[32:33], v[130:131] op_sel_hi:[1,0,1]
v_pk_fma_f32 v[132:133], v[20:21], v[32:33], v[132:133] op_sel_hi:[1,0,1]
v_pk_fma_f32 v[134:135], v[22:23], v[32:33], v[134:135] op_sel_hi:[1,0,1]
v_pk_mul_f32 v[64:65], v[128:129], v[128:129]
v_pk_mul_f32 v[66:67], v[130:131], v[130:131]
v_pk_mul_f32 v[68:69], v[132:133], v[132:133]
v_pk_mul_f32 v[70:71], v[134:135], v[134:135]
v_pk_fma_f32 v[64:65], v[64:65], v[34:35], v[32:33] op_sel:[0,0,1] op_sel_hi:[1,0,1]
v_pk_fma_f32 v[66:67], v[66:67], v[34:35], v[32:33] op_sel:[0,0,1] op_sel_hi:[1,0,1]
v_pk_fma_f32 v[68:69], v[68:69], v[34:35], v[32:33] op_sel:[0,0,1] op_sel_hi:[1,0,1]
v_pk_fma_f32 v[70:71], v[70:71], v[34:35], v[32:33] op_sel:[0,0,1] op_sel_hi:[1,0,1]
v_pk_mul_f32 v[64:65], v[64:65], v[128:129]
v_pk_mul_f32 v[66:67], v[66:67], v[130:131]
v_pk_mul_f32 v[68:69], v[68:69], v[132:133]
v_pk_mul_f32 v[70:71], v[70:71], v[134:135]
v_exp_f32 v64, v64
v_exp_f32 v65, v65
v_pk_fma_f32 v[136:137], v[24:25], v[32:33], v[136:137] op_sel_hi:[1,0,1]
v_exp_f32 v66, v66
v_exp_f32 v67, v67
v_pk_fma_f32 v[138:139], v[26:27], v[32:33], v[138:139] op_sel_hi:[1,0,1]
v_exp_f32 v68, v68
v_exp_f32 v69, v69
v_pk_fma_f32 v[140:141], v[28:29], v[32:33], v[140:141] op_sel_hi:[1,0,1]
v_exp_f32 v70, v70
v_exp_f32 v71, v71
v_pk_fma_f32 v[142:143], v[30:31], v[32:33], v[142:143] op_sel_hi:[1,0,1]
v_pk_fma_f32 v[64:65], v[64:65], v[34:35], v[34:35] op_sel:[0,1,1] op_sel_hi:[1,1,1]
v_pk_fma_f32 v[66:67], v[66:67], v[34:35], v[34:35] op_sel:[0,1,1] op_sel_hi:[1,1,1]
v_pk_fma_f32 v[68:69], v[68:69], v[34:35], v[34:35] op_sel:[0,1,1] op_sel_hi:[1,1,1]
v_pk_fma_f32 v[70:71], v[70:71], v[34:35], v[34:35] op_sel:[0,1,1] op_sel_hi:[1,1,1]
v_rcp_f32 v64, v64
v_rcp_f32 v65, v65
v_pk_mul_f32 v[136:137], v[136:137], v[128:129]
v_rcp_f32 v66, v66
v_rcp_f32 v67, v67
v_pk_mul_f32 v[138:139], v[138:139], v[130:131]
v_rcp_f32 v68, v68
v_rcp_f32 v69, v69
v_pk_mul_f32 v[140:141], v[140:141], v[132:133]
v_rcp_f32 v70, v70
v_rcp_f32 v71, v71
v_pk_mul_f32 v[142:143], v[142:143], v[134:135]
v_pk_mul_f32 v[64:65], v[64:65], v[136:137]
v_pk_mul_f32 v[66:67], v[66:67], v[138:139]
v_pk_mul_f32 v[68:69], v[68:69], v[140:141]
v_pk_mul_f32 v[70:71], v[70:71], v[142:143]
v_cvt_pk_bf16_f32 v80, v64, v65
v_cvt_pk_bf16_f32 v81, v66, v67
v_cvt_pk_bf16_f32 v82, v68, v69
v_cvt_pk_bf16_f32 v83, v70, v71
buffer_store_dwordx4 v[80:83], v112, s[24:27], s74 offen sc1
s_add_u32 s74, s74, 55296
v_pk_fma_f32 v[144:145], v[16:17], v[36:37], v[144:145] op_sel_hi:[1,0,1]
v_pk_fma_f32 v[146:147], v[18:19], v[36:37], v[146:147] op_sel_hi:[1,0,1]
v_pk_fma_f32 v[148:149], v[20:21], v[36:37], v[148:149] op_sel_hi:[1,0,1]
v_pk_fma_f32 v[150:151], v[22:23], v[36:37], v[150:151] op_sel_hi:[1,0,1]
v_pk_mul_f32 v[72:73], v[144:145], v[144:145]
v_pk_mul_f32 v[74:75], v[146:147], v[146:147]
v_pk_mul_f32 v[76:77], v[148:149], v[148:149]
v_pk_mul_f32 v[78:79], v[150:151], v[150:151]
v_pk_fma_f32 v[72:73], v[72:73], v[38:39], v[36:37] op_sel:[0,0,1] op_sel_hi:[1,0,1]
v_pk_fma_f32 v[74:75], v[74:75], v[38:39], v[36:37] op_sel:[0,0,1] op_sel_hi:[1,0,1]
v_pk_fma_f32 v[76:77], v[76:77], v[38:39], v[36:37] op_sel:[0,0,1] op_sel_hi:[1,0,1]
v_pk_fma_f32 v[78:79], v[78:79], v[38:39], v[36:37] op_sel:[0,0,1] op_sel_hi:[1,0,1]
v_pk_mul_f32 v[72:73], v[72:73], v[144:145]
v_pk_mul_f32 v[74:75], v[74:75], v[146:147]
v_pk_mul_f32 v[76:77], v[76:77], v[148:149]
v_pk_mul_f32 v[78:79], v[78:79], v[150:151]
v_exp_f32 v72, v72
v_exp_f32 v73, v73
v_pk_fma_f32 v[152:153], v[24:25], v[36:37], v[152:153] op_sel_hi:[1,0,1]
v_exp_f32 v74, v74
v_exp_f32 v75, v75
v_pk_fma_f32 v[154:155], v[26:27], v[36:37], v[154:155] op_sel_hi:[1,0,1]
v_exp_f32 v76, v76
v_exp_f32 v77, v77
v_pk_fma_f32 v[156:157], v[28:29], v[36:37], v[156:157] op_sel_hi:[1,0,1]
v_exp_f32 v78, v78
v_exp_f32 v79, v79
v_pk_fma_f32 v[158:159], v[30:31], v[36:37], v[158:159] op_sel_hi:[1,0,1]
v_pk_fma_f32 v[72:73], v[72:73], v[38:39], v[38:39] op_sel:[0,1,1] op_sel_hi:[1,1,1]
v_pk_fma_f32 v[74:75], v[74:75], v[38:39], v[38:39] op_sel:[0,1,1] op_sel_hi:[1,1,1]
v_pk_fma_f32 v[76:77], v[76:77], v[38:39], v[38:39] op_sel:[0,1,1] op_sel_hi:[1,1,1]
v_pk_fma_f32 v[78:79], v[78:79], v[38:39], v[38:39] op_sel:[0,1,1] op_sel_hi:[1,1,1]
v_rcp_f32 v72, v72
v_rcp_f32 v73, v73
v_pk_mul_f32 v[152:153], v[152:153], v[144:145]
v_rcp_f32 v74, v74
v_rcp_f32 v75, v75
v_pk_mul_f32 v[154:155], v[154:155], v[146:147]
v_rcp_f32 v76, v76
v_rcp_f32 v77, v77
v_pk_mul_f32 v[156:157], v[156:157], v[148:149]
v_rcp_f32 v78, v78
v_rcp_f32 v79, v79
v_pk_mul_f32 v[158:159], v[158:159], v[150:151]
v_pk_mul_f32 v[72:73], v[72:73], v[152:153]
v_pk_mul_f32 v[74:75], v[74:75], v[154:155]
v_pk_mul_f32 v[76:77], v[76:77], v[156:157]
v_pk_mul_f32 v[78:79], v[78:79], v[158:159]
v_cvt_pk_bf16_f32 v84, v72, v73
v_cvt_pk_bf16_f32 v85, v74, v75
v_cvt_pk_bf16_f32 v86, v76, v77
v_cvt_pk_bf16_f32 v87, v78, v79
buffer_store_dwordx4 v[84:87], v112, s[24:27], s74 offen sc1
s_add_u32 s74, s74, 55296
v_pk_fma_f32 v[160:161], v[16:17], v[40:41], v[160:161] op_sel_hi:[1,0,1]
v_pk_fma_f32 v[162:163], v[18:19], v[40:41], v[162:163] op_sel_hi:[1,0,1]
v_pk_fma_f32 v[164:165], v[20:21], v[40:41], v[164:165] op_sel_hi:[1,0,1]
v_pk_fma_f32 v[166:167], v[22:23], v[40:41], v[166:167] op_sel_hi:[1,0,1]
v_pk_mul_f32 v[64:65], v[160:161], v[160:161]
v_pk_mul_f32 v[66:67], v[162:163], v[162:163]
v_pk_mul_f32 v[68:69], v[164:165], v[164:165]
v_pk_mul_f32 v[70:71], v[166:167], v[166:167]
v_pk_fma_f32 v[64:65], v[64:65], v[42:43], v[40:41] op_sel:[0,0,1] op_sel_hi:[1,0,1]
v_pk_fma_f32 v[66:67], v[66:67], v[42:43], v[40:41] op_sel:[0,0,1] op_sel_hi:[1,0,1]
v_pk_fma_f32 v[68:69], v[68:69], v[42:43], v[40:41] op_sel:[0,0,1] op_sel_hi:[1,0,1]
v_pk_fma_f32 v[70:71], v[70:71], v[42:43], v[40:41] op_sel:[0,0,1] op_sel_hi:[1,0,1]
v_pk_mul_f32 v[64:65], v[64:65], v[160:161]
v_pk_mul_f32 v[66:67], v[66:67], v[162:163]
v_pk_mul_f32 v[68:69], v[68:69], v[164:165]
v_pk_mul_f32 v[70:71], v[70:71], v[166:167]
v_exp_f32 v64, v64
v_exp_f32 v65, v65
v_pk_fma_f32 v[168:169], v[24:25], v[40:41], v[168:169] op_sel_hi:[1,0,1]
v_exp_f32 v66, v66
v_exp_f32 v67, v67
v_pk_fma_f32 v[170:171], v[26:27], v[40:41], v[170:171] op_sel_hi:[1,0,1]
v_exp_f32 v68, v68
v_exp_f32 v69, v69
v_pk_fma_f32 v[172:173], v[28:29], v[40:41], v[172:173] op_sel_hi:[1,0,1]
v_exp_f32 v70, v70
v_exp_f32 v71, v71
v_pk_fma_f32 v[174:175], v[30:31], v[40:41], v[174:175] op_sel_hi:[1,0,1]
v_pk_fma_f32 v[64:65], v[64:65], v[42:43], v[42:43] op_sel:[0,1,1] op_sel_hi:[1,1,1]
v_pk_fma_f32 v[66:67], v[66:67], v[42:43], v[42:43] op_sel:[0,1,1] op_sel_hi:[1,1,1]
v_pk_fma_f32 v[68:69], v[68:69], v[42:43], v[42:43] op_sel:[0,1,1] op_sel_hi:[1,1,1]
v_pk_fma_f32 v[70:71], v[70:71], v[42:43], v[42:43] op_sel:[0,1,1] op_sel_hi:[1,1,1]
v_rcp_f32 v64, v64
v_rcp_f32 v65, v65
v_pk_mul_f32 v[168:169], v[168:169], v[160:161]
v_rcp_f32 v66, v66
v_rcp_f32 v67, v67
v_pk_mul_f32 v[170:171], v[170:171], v[162:163]
v_rcp_f32 v68, v68
v_rcp_f32 v69, v69
v_pk_mul_f32 v[172:173], v[172:173], v[164:165]
v_rcp_f32 v70, v70
v_rcp_f32 v71, v71
v_pk_mul_f32 v[174:175], v[174:175], v[166:167]
v_pk_mul_f32 v[64:65], v[64:65], v[168:169]
v_pk_mul_f32 v[66:67], v[66:67], v[170:171]
v_pk_mul_f32 v[68:69], v[68:69], v[172:173]
v_pk_mul_f32 v[70:71], v[70:71], v[174:175]
v_cvt_pk_bf16_f32 v88, v64, v65
v_cvt_pk_bf16_f32 v89, v66, v67
v_cvt_pk_bf16_f32 v90, v68, v69
v_cvt_pk_bf16_f32 v91, v70, v71
buffer_store_dwordx4 v[88:91], v112, s[24:27], s74 offen sc1
s_add_u32 s74, s74, 55296
v_pk_fma_f32 v[176:177], v[16:17], v[44:45], v[176:177] op_sel_hi:[1,0,1]
v_pk_fma_f32 v[178:179], v[18:19], v[44:45], v[178:179] op_sel_hi:[1,0,1]
v_pk_fma_f32 v[180:181], v[20:21], v[44:45], v[180:181] op_sel_hi:[1,0,1]
v_pk_fma_f32 v[182:183], v[22:23], v[44:45], v[182:183] op_sel_hi:[1,0,1]
v_pk_mul_f32 v[72:73], v[176:177], v[176:177]
v_pk_mul_f32 v[74:75], v[178:179], v[178:179]
v_pk_mul_f32 v[76:77], v[180:181], v[180:181]
v_pk_mul_f32 v[78:79], v[182:183], v[182:183]
v_pk_fma_f32 v[72:73], v[72:73], v[46:47], v[44:45] op_sel:[0,0,1] op_sel_hi:[1,0,1]
v_pk_fma_f32 v[74:75], v[74:75], v[46:47], v[44:45] op_sel:[0,0,1] op_sel_hi:[1,0,1]
v_pk_fma_f32 v[76:77], v[76:77], v[46:47], v[44:45] op_sel:[0,0,1] op_sel_hi:[1,0,1]
v_pk_fma_f32 v[78:79], v[78:79], v[46:47], v[44:45] op_sel:[0,0,1] op_sel_hi:[1,0,1]
v_pk_mul_f32 v[72:73], v[72:73], v[176:177]
v_pk_mul_f32 v[74:75], v[74:75], v[178:179]
v_pk_mul_f32 v[76:77], v[76:77], v[180:181]
v_pk_mul_f32 v[78:79], v[78:79], v[182:183]
v_exp_f32 v72, v72
v_exp_f32 v73, v73
v_pk_fma_f32 v[184:185], v[24:25], v[44:45], v[184:185] op_sel_hi:[1,0,1]
v_exp_f32 v74, v74
v_exp_f32 v75, v75
v_pk_fma_f32 v[186:187], v[26:27], v[44:45], v[186:187] op_sel_hi:[1,0,1]
v_exp_f32 v76, v76
v_exp_f32 v77, v77
v_pk_fma_f32 v[188:189], v[28:29], v[44:45], v[188:189] op_sel_hi:[1,0,1]
v_exp_f32 v78, v78
v_exp_f32 v79, v79
v_pk_fma_f32 v[190:191], v[30:31], v[44:45], v[190:191] op_sel_hi:[1,0,1]
v_pk_fma_f32 v[72:73], v[72:73], v[46:47], v[46:47] op_sel:[0,1,1] op_sel_hi:[1,1,1]
v_pk_fma_f32 v[74:75], v[74:75], v[46:47], v[46:47] op_sel:[0,1,1] op_sel_hi:[1,1,1]
v_pk_fma_f32 v[76:77], v[76:77], v[46:47], v[46:47] op_sel:[0,1,1] op_sel_hi:[1,1,1]
v_pk_fma_f32 v[78:79], v[78:79], v[46:47], v[46:47] op_sel:[0,1,1] op_sel_hi:[1,1,1]
v_rcp_f32 v72, v72
v_rcp_f32 v73, v73
v_pk_mul_f32 v[184:185], v[184:185], v[176:177]
v_rcp_f32 v74, v74
v_rcp_f32 v75, v75
v_pk_mul_f32 v[186:187], v[186:187], v[178:179]
v_rcp_f32 v76, v76
v_rcp_f32 v77, v77
v_pk_mul_f32 v[188:189], v[188:189], v[180:181]
v_rcp_f32 v78, v78
v_rcp_f32 v79, v79
v_pk_mul_f32 v[190:191], v[190:191], v[182:183]
v_pk_mul_f32 v[72:73], v[72:73], v[184:185]
v_pk_mul_f32 v[74:75], v[74:75], v[186:187]
v_pk_mul_f32 v[76:77], v[76:77], v[188:189]
v_pk_mul_f32 v[78:79], v[78:79], v[190:191]
v_cvt_pk_bf16_f32 v92, v72, v73
v_cvt_pk_bf16_f32 v93, v74, v75
v_cvt_pk_bf16_f32 v94, v76, v77
v_cvt_pk_bf16_f32 v95, v78, v79
buffer_store_dwordx4 v[92:95], v112, s[24:27], s74 offen sc1
s_add_u32 s74, s74, 55296
v_pk_fma_f32 v[192:193], v[16:17], v[48:49], v[192:193] op_sel_hi:[1,0,1]
v_pk_fma_f32 v[194:195], v[18:19], v[48:49], v[194:195] op_sel_hi:[1,0,1]
v_pk_fma_f32 v[196:197], v[20:21], v[48:49], v[196:197] op_sel_hi:[1,0,1]
v_pk_fma_f32 v[198:199], v[22:23], v[48:49], v[198:199] op_sel_hi:[1,0,1]
v_pk_mul_f32 v[64:65], v[192:193], v[192:193]
v_pk_mul_f32 v[66:67], v[194:195], v[194:195]
v_pk_mul_f32 v[68:69], v[196:197], v[196:197]
v_pk_mul_f32 v[70:71], v[198:199], v[198:199]
v_pk_fma_f32 v[64:65], v[64:65], v[50:51], v[48:49] op_sel:[0,0,1] op_sel_hi:[1,0,1]
v_pk_fma_f32 v[66:67], v[66:67], v[50:51], v[48:49] op_sel:[0,0,1] op_sel_hi:[1,0,1]
v_pk_fma_f32 v[68:69], v[68:69], v[50:51], v[48:49] op_sel:[0,0,1] op_sel_hi:[1,0,1]
v_pk_fma_f32 v[70:71], v[70:71], v[50:51], v[48:49] op_sel:[0,0,1] op_sel_hi:[1,0,1]
v_pk_mul_f32 v[64:65], v[64:65], v[192:193]
v_pk_mul_f32 v[66:67], v[66:67], v[194:195]
v_pk_mul_f32 v[68:69], v[68:69], v[196:197]
v_pk_mul_f32 v[70:71], v[70:71], v[198:199]
v_exp_f32 v64, v64
v_exp_f32 v65, v65
v_pk_fma_f32 v[200:201], v[24:25], v[48:49], v[200:201] op_sel_hi:[1,0,1]
v_exp_f32 v66, v66
v_exp_f32 v67, v67
v_pk_fma_f32 v[202:203], v[26:27], v[48:49], v[202:203] op_sel_hi:[1,0,1]
v_exp_f32 v68, v68
v_exp_f32 v69, v69
v_pk_fma_f32 v[204:205], v[28:29], v[48:49], v[204:205] op_sel_hi:[1,0,1]
v_exp_f32 v70, v70
v_exp_f32 v71, v71
v_pk_fma_f32 v[206:207], v[30:31], v[48:49], v[206:207] op_sel_hi:[1,0,1]
v_pk_fma_f32 v[64:65], v[64:65], v[50:51], v[50:51] op_sel:[0,1,1] op_sel_hi:[1,1,1]
v_pk_fma_f32 v[66:67], v[66:67], v[50:51], v[50:51] op_sel:[0,1,1] op_sel_hi:[1,1,1]
v_pk_fma_f32 v[68:69], v[68:69], v[50:51], v[50:51] op_sel:[0,1,1] op_sel_hi:[1,1,1]
v_pk_fma_f32 v[70:71], v[70:71], v[50:51], v[50:51] op_sel:[0,1,1] op_sel_hi:[1,1,1]
v_rcp_f32 v64, v64
v_rcp_f32 v65, v65
v_pk_mul_f32 v[200:201], v[200:201], v[192:193]
v_rcp_f32 v66, v66
v_rcp_f32 v67, v67
v_pk_mul_f32 v[202:203], v[202:203], v[194:195]
v_rcp_f32 v68, v68
v_rcp_f32 v69, v69
v_pk_mul_f32 v[204:205], v[204:205], v[196:197]
v_rcp_f32 v70, v70
v_rcp_f32 v71, v71
v_pk_mul_f32 v[206:207], v[206:207], v[198:199]
v_pk_mul_f32 v[64:65], v[64:65], v[200:201]
v_pk_mul_f32 v[66:67], v[66:67], v[202:203]
v_pk_mul_f32 v[68:69], v[68:69], v[204:205]
v_pk_mul_f32 v[70:71], v[70:71], v[206:207]
v_cvt_pk_bf16_f32 v80, v64, v65
v_cvt_pk_bf16_f32 v81, v66, v67
v_cvt_pk_bf16_f32 v82, v68, v69
v_cvt_pk_bf16_f32 v83, v70, v71
buffer_store_dwordx4 v[80:83], v112, s[24:27], s74 offen sc1
s_add_u32 s74, s74, 55296
v_pk_fma_f32 v[208:209], v[16:17], v[52:53], v[208:209] op_sel_hi:[1,0,1]
v_pk_fma_f32 v[210:211], v[18:19], v[52:53], v[210:211] op_sel_hi:[1,0,1]
v_pk_fma_f32 v[212:213], v[20:21], v[52:53], v[212:213] op_sel_hi:[1,0,1]
v_pk_fma_f32 v[214:215], v[22:23], v[52:53], v[214:215] op_sel_hi:[1,0,1]
v_pk_mul_f32 v[72:73], v[208:209], v[208:209]
v_pk_mul_f32 v[74:75], v[210:211], v[210:211]
v_pk_mul_f32 v[76:77], v[212:213], v[212:213]
v_pk_mul_f32 v[78:79], v[214:215], v[214:215]
v_pk_fma_f32 v[72:73], v[72:73], v[54:55], v[52:53] op_sel:[0,0,1] op_sel_hi:[1,0,1]
v_pk_fma_f32 v[74:75], v[74:75], v[54:55], v[52:53] op_sel:[0,0,1] op_sel_hi:[1,0,1]
v_pk_fma_f32 v[76:77], v[76:77], v[54:55], v[52:53] op_sel:[0,0,1] op_sel_hi:[1,0,1]
v_pk_fma_f32 v[78:79], v[78:79], v[54:55], v[52:53] op_sel:[0,0,1] op_sel_hi:[1,0,1]
v_pk_mul_f32 v[72:73], v[72:73], v[208:209]
v_pk_mul_f32 v[74:75], v[74:75], v[210:211]
v_pk_mul_f32 v[76:77], v[76:77], v[212:213]
v_pk_mul_f32 v[78:79], v[78:79], v[214:215]
v_exp_f32 v72, v72
v_exp_f32 v73, v73
v_pk_fma_f32 v[216:217], v[24:25], v[52:53], v[216:217] op_sel_hi:[1,0,1]
v_exp_f32 v74, v74
v_exp_f32 v75, v75
v_pk_fma_f32 v[218:219], v[26:27], v[52:53], v[218:219] op_sel_hi:[1,0,1]
v_exp_f32 v76, v76
v_exp_f32 v77, v77
v_pk_fma_f32 v[220:221], v[28:29], v[52:53], v[220:221] op_sel_hi:[1,0,1]
v_exp_f32 v78, v78
v_exp_f32 v79, v79
v_pk_fma_f32 v[222:223], v[30:31], v[52:53], v[222:223] op_sel_hi:[1,0,1]
v_pk_fma_f32 v[72:73], v[72:73], v[54:55], v[54:55] op_sel:[0,1,1] op_sel_hi:[1,1,1]
v_pk_fma_f32 v[74:75], v[74:75], v[54:55], v[54:55] op_sel:[0,1,1] op_sel_hi:[1,1,1]
v_pk_fma_f32 v[76:77], v[76:77], v[54:55], v[54:55] op_sel:[0,1,1] op_sel_hi:[1,1,1]
v_pk_fma_f32 v[78:79], v[78:79], v[54:55], v[54:55] op_sel:[0,1,1] op_sel_hi:[1,1,1]
v_rcp_f32 v72, v72
v_rcp_f32 v73, v73
v_pk_mul_f32 v[216:217], v[216:217], v[208:209]
v_rcp_f32 v74, v74
v_rcp_f32 v75, v75
v_pk_mul_f32 v[218:219], v[218:219], v[210:211]
v_rcp_f32 v76, v76
v_rcp_f32 v77, v77
v_pk_mul_f32 v[220:221], v[220:221], v[212:213]
v_rcp_f32 v78, v78
v_rcp_f32 v79, v79
v_pk_mul_f32 v[222:223], v[222:223], v[214:215]
v_pk_mul_f32 v[72:73], v[72:73], v[216:217]
v_pk_mul_f32 v[74:75], v[74:75], v[218:219]
v_pk_mul_f32 v[76:77], v[76:77], v[220:221]
v_pk_mul_f32 v[78:79], v[78:79], v[222:223]
v_cvt_pk_bf16_f32 v84, v72, v73
v_cvt_pk_bf16_f32 v85, v74, v75
v_cvt_pk_bf16_f32 v86, v76, v77
v_cvt_pk_bf16_f32 v87, v78, v79
buffer_store_dwordx4 v[84:87], v112, s[24:27], s74 offen sc1
s_add_u32 s74, s74, 55296
v_pk_fma_f32 v[224:225], v[16:17], v[56:57], v[224:225] op_sel_hi:[1,0,1]
v_pk_fma_f32 v[226:227], v[18:19], v[56:57], v[226:227] op_sel_hi:[1,0,1]
v_pk_fma_f32 v[228:229], v[20:21], v[56:57], v[228:229] op_sel_hi:[1,0,1]
v_pk_fma_f32 v[230:231], v[22:23], v[56:57], v[230:231] op_sel_hi:[1,0,1]
v_pk_mul_f32 v[64:65], v[224:225], v[224:225]
v_pk_mul_f32 v[66:67], v[226:227], v[226:227]
v_pk_mul_f32 v[68:69], v[228:229], v[228:229]
v_pk_mul_f32 v[70:71], v[230:231], v[230:231]
v_pk_fma_f32 v[64:65], v[64:65], v[58:59], v[56:57] op_sel:[0,0,1] op_sel_hi:[1,0,1]
v_pk_fma_f32 v[66:67], v[66:67], v[58:59], v[56:57] op_sel:[0,0,1] op_sel_hi:[1,0,1]
v_pk_fma_f32 v[68:69], v[68:69], v[58:59], v[56:57] op_sel:[0,0,1] op_sel_hi:[1,0,1]
v_pk_fma_f32 v[70:71], v[70:71], v[58:59], v[56:57] op_sel:[0,0,1] op_sel_hi:[1,0,1]
v_pk_mul_f32 v[64:65], v[64:65], v[224:225]
v_pk_mul_f32 v[66:67], v[66:67], v[226:227]
v_pk_mul_f32 v[68:69], v[68:69], v[228:229]
v_pk_mul_f32 v[70:71], v[70:71], v[230:231]
v_exp_f32 v64, v64
v_exp_f32 v65, v65
v_pk_fma_f32 v[232:233], v[24:25], v[56:57], v[232:233] op_sel_hi:[1,0,1]
v_exp_f32 v66, v66
v_exp_f32 v67, v67
v_pk_fma_f32 v[234:235], v[26:27], v[56:57], v[234:235] op_sel_hi:[1,0,1]
v_exp_f32 v68, v68
v_exp_f32 v69, v69
v_pk_fma_f32 v[236:237], v[28:29], v[56:57], v[236:237] op_sel_hi:[1,0,1]
v_exp_f32 v70, v70
v_exp_f32 v71, v71
v_pk_fma_f32 v[238:239], v[30:31], v[56:57], v[238:239] op_sel_hi:[1,0,1]
v_pk_fma_f32 v[64:65], v[64:65], v[58:59], v[58:59] op_sel:[0,1,1] op_sel_hi:[1,1,1]
v_pk_fma_f32 v[66:67], v[66:67], v[58:59], v[58:59] op_sel:[0,1,1] op_sel_hi:[1,1,1]
v_pk_fma_f32 v[68:69], v[68:69], v[58:59], v[58:59] op_sel:[0,1,1] op_sel_hi:[1,1,1]
v_pk_fma_f32 v[70:71], v[70:71], v[58:59], v[58:59] op_sel:[0,1,1] op_sel_hi:[1,1,1]
v_rcp_f32 v64, v64
v_rcp_f32 v65, v65
v_pk_mul_f32 v[232:233], v[232:233], v[224:225]
v_rcp_f32 v66, v66
v_rcp_f32 v67, v67
v_pk_mul_f32 v[234:235], v[234:235], v[226:227]
v_rcp_f32 v68, v68
v_rcp_f32 v69, v69
v_pk_mul_f32 v[236:237], v[236:237], v[228:229]
v_rcp_f32 v70, v70
v_rcp_f32 v71, v71
v_pk_mul_f32 v[238:239], v[238:239], v[230:231]
v_pk_mul_f32 v[64:65], v[64:65], v[232:233]
v_pk_mul_f32 v[66:67], v[66:67], v[234:235]
v_pk_mul_f32 v[68:69], v[68:69], v[236:237]
v_pk_mul_f32 v[70:71], v[70:71], v[238:239]
v_cvt_pk_bf16_f32 v88, v64, v65
v_cvt_pk_bf16_f32 v89, v66, v67
v_cvt_pk_bf16_f32 v90, v68, v69
v_cvt_pk_bf16_f32 v91, v70, v71
buffer_store_dwordx4 v[88:91], v112, s[24:27], s74 offen sc1
s_add_u32 s74, s74, 55296
v_pk_fma_f32 v[240:241], v[16:17], v[60:61], v[240:241] op_sel_hi:[1,0,1]
v_pk_fma_f32 v[242:243], v[18:19], v[60:61], v[242:243] op_sel_hi:[1,0,1]
v_pk_fma_f32 v[244:245], v[20:21], v[60:61], v[244:245] op_sel_hi:[1,0,1]
v_pk_fma_f32 v[246:247], v[22:23], v[60:61], v[246:247] op_sel_hi:[1,0,1]
v_pk_mul_f32 v[72:73], v[240:241], v[240:241]
v_pk_mul_f32 v[74:75], v[242:243], v[242:243]
v_pk_mul_f32 v[76:77], v[244:245], v[244:245]
v_pk_mul_f32 v[78:79], v[246:247], v[246:247]
v_pk_fma_f32 v[72:73], v[72:73], v[62:63], v[60:61] op_sel:[0,0,1] op_sel_hi:[1,0,1]
v_pk_fma_f32 v[74:75], v[74:75], v[62:63], v[60:61] op_sel:[0,0,1] op_sel_hi:[1,0,1]
v_pk_fma_f32 v[76:77], v[76:77], v[62:63], v[60:61] op_sel:[0,0,1] op_sel_hi:[1,0,1]
v_pk_fma_f32 v[78:79], v[78:79], v[62:63], v[60:61] op_sel:[0,0,1] op_sel_hi:[1,0,1]
v_pk_mul_f32 v[72:73], v[72:73], v[240:241]
v_pk_mul_f32 v[74:75], v[74:75], v[242:243]
v_pk_mul_f32 v[76:77], v[76:77], v[244:245]
v_pk_mul_f32 v[78:79], v[78:79], v[246:247]
v_exp_f32 v72, v72
v_exp_f32 v73, v73
v_pk_fma_f32 v[248:249], v[24:25], v[60:61], v[248:249] op_sel_hi:[1,0,1]
v_exp_f32 v74, v74
v_exp_f32 v75, v75
v_pk_fma_f32 v[250:251], v[26:27], v[60:61], v[250:251] op_sel_hi:[1,0,1]
v_exp_f32 v76, v76
v_exp_f32 v77, v77
v_pk_fma_f32 v[252:253], v[28:29], v[60:61], v[252:253] op_sel_hi:[1,0,1]
v_exp_f32 v78, v78
v_exp_f32 v79, v79
v_pk_fma_f32 v[254:255], v[30:31], v[60:61], v[254:255] op_sel_hi:[1,0,1]
v_pk_fma_f32 v[72:73], v[72:73], v[62:63], v[62:63] op_sel:[0,1,1] op_sel_hi:[1,1,1]
v_pk_fma_f32 v[74:75], v[74:75], v[62:63], v[62:63] op_sel:[0,1,1] op_sel_hi:[1,1,1]
v_pk_fma_f32 v[76:77], v[76:77], v[62:63], v[62:63] op_sel:[0,1,1] op_sel_hi:[1,1,1]
v_pk_fma_f32 v[78:79], v[78:79], v[62:63], v[62:63] op_sel:[0,1,1] op_sel_hi:[1,1,1]
v_rcp_f32 v72, v72
v_rcp_f32 v73, v73
v_pk_mul_f32 v[248:249], v[248:249], v[240:241]
v_rcp_f32 v74, v74
v_rcp_f32 v75, v75
v_pk_mul_f32 v[250:251], v[250:251], v[242:243]
v_rcp_f32 v76, v76
v_rcp_f32 v77, v77
v_pk_mul_f32 v[252:253], v[252:253], v[244:245]
v_rcp_f32 v78, v78
v_rcp_f32 v79, v79
v_pk_mul_f32 v[254:255], v[254:255], v[246:247]
v_pk_mul_f32 v[72:73], v[72:73], v[248:249]
v_pk_mul_f32 v[74:75], v[74:75], v[250:251]
v_pk_mul_f32 v[76:77], v[76:77], v[252:253]
v_pk_mul_f32 v[78:79], v[78:79], v[254:255]
v_cvt_pk_bf16_f32 v92, v72, v73
v_cvt_pk_bf16_f32 v93, v74, v75
v_cvt_pk_bf16_f32 v94, v76, v77
v_cvt_pk_bf16_f32 v95, v78, v79
buffer_store_dwordx4 v[92:95], v112, s[24:27], s74 offen sc1
s_lshl_b32 s100, s3, 2
s_add_u32 s100, s100, 163312
v_mov_b32 v14, s100
ds_write_b32 v14, v14

s_setprio 0
s_waitcnt vmcnt(0)
v_mov_b32 v15, s6
s_mov_b64 exec, 1
buffer_store_dword v15, off, s[24:27], s93 sc1
s_mov_b64 exec, -1

v_add_u32 v120, s87, v2
v_lshlrev_b32 v120, 3, v120
s_mov_b32 s100, 17563648
buffer_load_dwordx2 v[118:119], v120, s[24:27], s100 offen sc1

v_lshlrev_b32 v14, 3, v3
v_sub_u32 v14, v113, v14
buffer_load_dwordx4 v[4:7], v113, s[8:11], 0 offen offset:0
buffer_load_dwordx4 v[8:11], v113, s[8:11], 0 offen offset:64
buffer_load_dwordx2 v[12:13], v14, s[8:11], 0 offen offset:128
buffer_load_dwordx4 v[128:131], v112, s[24:27], s91 offen offset:0
buffer_load_dwordx4 v[132:135], v112, s[24:27], s91 offen offset:1024
buffer_load_dwordx4 v[136:139], v112, s[24:27], s91 offen offset:2048
buffer_load_dwordx4 v[140:143], v112, s[24:27], s91 offen offset:3072
s_add_u32 s91, s91, 4096
buffer_load_dwordx4 v[144:147], v112, s[24:27], s91 offen
s_cmp_eq_u32 s0, 0
s_cselect_b32 s99, s60, 16384
s_add_u32 s91, s91, s99
buffer_load_dwordx4 v[148:151], v112, s[24:27], s91 offen offset:0
buffer_load_dwordx4 v[152:155], v112, s[24:27], s91 offen offset:1024
buffer_load_dwordx4 v[156:159], v112, s[24:27], s91 offen offset:2048
buffer_load_dwordx4 v[160:163], v112, s[24:27], s91 offen offset:3072
s_add_u32 s91, s91, 4096
buffer_load_dwordx4 v[164:167], v112, s[24:27], s91 offen
s_cmp_eq_u32 s0, 1
s_cselect_b32 s99, s60, 16384
s_add_u32 s91, s91, s99
buffer_load_dwordx4 v[168:171], v112, s[24:27], s91 offen offset:0
buffer_load_dwordx4 v[172:175], v112, s[24:27], s91 offen offset:1024
buffer_load_dwordx4 v[176:179], v112, s[24:27], s91 offen offset:2048
buffer_load_dwordx4 v[180:183], v112, s[24:27], s91 offen offset:3072
s_add_u32 s91, s91, 4096
buffer_load_dwordx4 v[184:187], v112, s[24:27], s91 offen
s_cmp_eq_u32 s0, 2
s_cselect_b32 s99, s60, 16384
s_add_u32 s91, s91, s99
buffer_load_dwordx4 v[188:191], v112, s[24:27], s91 offen offset:0
buffer_load_dwordx4 v[192:195], v112, s[24:27], s91 offen offset:1024
buffer_load_dwordx4 v[196:199], v112, s[24:27], s91 offen offset:2048
buffer_load_dwordx4 v[200:203], v112, s[24:27], s91 offen offset:3072
s_add_u32 s91, s91, 4096
buffer_load_dwordx4 v[204:207], v112, s[24:27], s91 offen
s_cmp_eq_u32 s0, 3
s_cselect_b32 s99, s60, 16384
s_add_u32 s91, s91, s99
buffer_load_dwordx4 v[208:211], v112, s[24:27], s91 offen offset:0
buffer_load_dwordx4 v[212:215], v112, s[24:27], s91 offen offset:1024
buffer_load_dwordx4 v[216:219], v112, s[24:27], s91 offen offset:2048
buffer_load_dwordx4 v[220:223], v112, s[24:27], s91 offen offset:3072
s_add_u32 s91, s91, 4096
buffer_load_dwordx4 v[224:227], v112, s[24:27], s91 offen
s_cmp_eq_u32 s0, 4
s_cselect_b32 s99, s60, 16384
s_add_u32 s91, s91, s99
buffer_load_dwordx4 v[228:231], v112, s[24:27], s91 offen offset:0
buffer_load_dwordx4 v[232:235], v112, s[24:27], s91 offen offset:1024
buffer_load_dwordx4 v[236:239], v112, s[24:27], s91 offen offset:2048
buffer_load_dwordx4 v[240:243], v112, s[24:27], s91 offen offset:3072
s_add_u32 s91, s91, 4096
buffer_load_dwordx4 v[244:247], v112, s[24:27], s91 offen
s_cmp_eq_u32 s0, 5
s_cselect_b32 s99, s60, 16384
s_add_u32 s91, s91, s99
s_mov_b32 s93, 0
s_cmp_ge_u32 s3, 2
s_cbranch_scc1 L_wsd_15
s_mov_b32 s93, 154624
s_mov_b32 s92, 4096
s_cmp_eq_u32 s3, 1
s_cselect_b32 s93, 150528, s93
s_cselect_b32 s92, 11712, s92
s_lshl_b32 s100, s3, 2
s_add_u32 s100, s100, 162176
v_mov_b32 v14, s100
s_mov_b32 s74, 65536
L_wsw_14:
ds_read_b32 v15, v14
s_waitcnt lgkmcnt(0)
v_readfirstlane_b32 s100, v15
s_cmp_lg_u32 s100, 0
s_cbranch_scc1 L_wsd_15
s_sleep 1
s_sub_u32 s74, s74, 1
s_cmp_lg_u32 s74, 0
s_cbranch_scc1 L_wsw_14
L_wsd_15:

s_lshr_b32 s96, s36, 1
s_lshl_b32 s96, s96, 14
s_add_u32 s96, s96, 17661952
s_ff1_i32_b64 s100, s[88:89]
v_cmp_gt_u32 vcc, 7, v1
s_nop 1
v_cndmask_b32 v14, 0, v1, vcc
v_lshl_add_u32 v14, v14, 2, s100
v_cmp_gt_u32 vcc, 54, v14
v_mov_b32 v15, s100
s_nop 0
v_cndmask_b32 v14, v15, v14, vcc
v_lshlrev_b32 v14, 8, v14
s_mov_b32 s90, 0
s_branch L_g2_go3

L_prep:
s_mov_b32 s63, 0
s_mov_b32 s8, s50
s_mov_b32 s9, s51
s_mov_b32 s10, 2621440
s_mov_b32 s11, 0x00020000
s_mov_b32 s12, s52
s_mov_b32 s13, s53
s_mov_b32 s14, 2621440
s_mov_b32 s15, 0x00020000
s_mov_b32 s16, s54
s_mov_b32 s17, s55
s_mov_b32 s18, 5120
s_mov_b32 s19, 0x00020000
s_mov_b32 s20, s56
s_mov_b32 s21, s57
s_mov_b32 s22, 2621440
s_mov_b32 s23, 0x00020000
s_mul_i32 s96, s4, 5
s_add_u32 s96, s96, s5
s_sub_u32 s86, s96, 27
s_mul_i32 s97, s86, 52
s_lshr_b32 s97, s97, 8
s_mul_i32 s98, s97, 5
s_sub_u32 s95, s86, s98
s_cmp_ge_u32 s3, 4
s_cselect_b32 s98, 5, 0
s_add_u32 s98, s98, s95
s_and_b32 s100, s3, 3
s_lshl_b32 s96, s97, 2
s_add_u32 s96, s96, s100
s_lshl_b32 s99, s96, 6
s_sub_u32 s100, s99, 4
s_mul_i32 s100, s100, 1280
s_lshl_b32 s101, s98, 7
s_add_u32 s100, s100, s101
v_lshrrev_b32 v8, 3, v1
v_and_b32 v9, 7, v1
v_mul_u32_u24 v13, 10240, v8
v_lshl_add_u32 v13, v9, 4, v13
v_add_u32 v13, s100, v13
v_add_u32 v14, 5120, v13
v_add_u32 v15, 10240, v13
s_lshl_b32 s87, s98, 9
v_lshlrev_b32 v10, 6, v9

s_cmp_ge_u32 s3, 4
s_cbranch_scc1 L_pr_a0

buffer_load_dwordx4 v[192:195], v10, s[16:19], s87 offen offset:0
buffer_load_dwordx4 v[196:199], v10, s[16:19], s87 offen offset:16
buffer_load_dwordx4 v[200:203], v10, s[16:19], s87 offen offset:32
buffer_load_dwordx4 v[204:207], v10, s[16:19], s87 offen offset:48
buffer_load_dwordx4 v[20:23], v13, s[8:11], 0 offen offset:1280
buffer_load_dwordx4 v[24:27], v13, s[8:11], 0 offen offset:2560
buffer_load_dwordx4 v[28:31], v13, s[8:11], 0 offen offset:3840
buffer_load_dwordx4 v[32:35], v14, s[8:11], 0 offen offset:0
buffer_load_dwordx4 v[64:67], v14, s[12:15], 0 offen offset:0
buffer_load_dwordx4 v[36:39], v14, s[8:11], 0 offen offset:1280
buffer_load_dwordx4 v[68:71], v14, s[12:15], 0 offen offset:1280
buffer_load_dwordx4 v[40:43], v14, s[8:11], 0 offen offset:2560
buffer_load_dwordx4 v[72:75], v14, s[12:15], 0 offen offset:2560
buffer_load_dwordx4 v[44:47], v14, s[8:11], 0 offen offset:3840
buffer_load_dwordx4 v[76:79], v14, s[12:15], 0 offen offset:3840
buffer_load_dwordx4 v[48:51], v15, s[8:11], 0 offen offset:0
buffer_load_dwordx4 v[80:83], v15, s[12:15], 0 offen offset:0
buffer_load_dwordx4 v[52:55], v15, s[8:11], 0 offen offset:1280
buffer_load_dwordx4 v[84:87], v15, s[12:15], 0 offen offset:1280
buffer_load_dwordx4 v[56:59], v15, s[8:11], 0 offen offset:2560
buffer_load_dwordx4 v[88:91], v15, s[12:15], 0 offen offset:2560
buffer_load_dwordx4 v[60:63], v15, s[8:11], 0 offen offset:3840
buffer_load_dwordx4 v[92:95], v15, s[12:15], 0 offen offset:3840
buffer_load_dword v124, off, s[40:43], 0 sc1
s_barrier
L_pr_a0:
s_mul_i32 s86, s86, 6
s_lshr_b32 s7, s3, 1
s_add_u32 s32, s86, s7
s_mul_i32 s33, s7, 25920

s_and_b32 s39, s3, 1
s_lshl_b32 s100, s39, 8
s_lshl_b32 s101, s39, 11
v_add_u32 v6, 1, v2
v_and_b32 v113, 3, v6
v_lshrrev_b32 v6, 2, v6
v_lshlrev_b32 v6, 4, v6
v_cmp_ne_u32 vcc, 0, v113
v_mul_u32_u24 v113, 4160, v113
v_add_u32 v113, v113, v6
v_cndmask_b32 v6, 0, 16, vcc
v_add_u32 v113, v113, v6
v_lshlrev_b32 v6, 4, v3
v_sub_u32 v113, v113, v6
v_add_u32 v113, 48, v113
v_add_u32 v113, s100, v113
v_and_b32 v114, 1, v2
v_cmp_eq_u32 vcc, 1, v114
v_lshrrev_b32 v114, 1, v2
v_lshlrev_b32 v114, 6, v114
v_add_u32 v114, v114, v6
v_mov_b32 v6, 21792
v_mov_b32 v4, 17152
v_cndmask_b32 v6, v6, v4, vcc
v_sub_u32 v114, v6, v114
v_add_u32 v114, s100, v114
v_lshlrev_b32 v6, 7, v3
v_lshl_add_u32 v117, v2, 2, v6
v_add_u32 v117, s101, v117
v_sub_u32 v115, 19148, v117
v_add_u32 v117, 8192, v117
v_lshlrev_b32 v112, 4, v1
s_lshl_b32 s100, s39, 1
v_and_b32 v5, 1, v3
v_add_u32 v5, s100, v5
v_add_u32 v6, v2, v5
v_subrev_u32 v6, 16, v6
v_lshlrev_b32 v118, 2, v6
v_cmp_gt_i32 vcc, 0, v6
v_mov_b32 v6, 0x7fff0000
s_nop 0
v_cndmask_b32 v118, v118, v6, vcc
v_cmp_ne_u32 vcc, 0, v5
v_mul_u32_u24 v116, 4160, v5
s_nop 0
v_cndmask_b32 v6, 0, 16, vcc
v_add_u32 v116, v116, v6
v_lshl_add_u32 v116, v2, 2, v116
v_cmp_gt_u32 vcc, 32, v1
v_mov_b32 v6, 24880
v_mov_b32 v4, 20752
v_cndmask_b32 v6, v6, v4, vcc
v_add_u32 v119, v6, v112
s_lshl_b32 s100, s7, 3
s_add_u32 s100, s100, 163264
v_mov_b32 v12, s100

s_cmp_lt_u32 s3, 4
s_cbranch_scc1 L_pr_a1
s_cmp_lg_u32 s3, 6
s_cbranch_scc1 L_pr_nz
v_mov_b32 v4, 163264
v_mov_b32 v96, 0
v_mov_b32 v97, 0
v_mov_b32 v98, 0
v_mov_b32 v99, 0
ds_write_b128 v4, v[96:99]
ds_write_b128 v4, v[96:99] offset:16
ds_write_b128 v4, v[96:99] offset:48
v_mov_b32 v4, 162176
ds_write_b128 v4, v[96:99]
ds_write_b128 v4, v[96:99] offset:16
ds_write_b128 v4, v[96:99] offset:32
s_waitcnt lgkmcnt(0)
L_pr_nz:
s_barrier
s_sub_u32 s84, s32, 2
s_sub_u32 s85, s33, 51840

s_lshl_b32 s100, s84, 12
buffer_load_dword v252, v118, s[20:23], s100 offen
s_lshl_b32 s101, s39, 3
s_add_u32 s100, s100, s101
s_mul_i32 s101, s39, 8336
s_add_u32 s101, s101, s85
s_add_u32 m0, s101, 64

s_nop 0
buffer_load_dwordx4 v112, s[20:23], s100 offen offset:0 lds
buffer_load_dwordx4 v112, s[20:23], s100 offen offset:1024 lds
buffer_load_dwordx4 v112, s[20:23], s100 offen offset:2048 lds
buffer_load_dwordx4 v112, s[20:23], s100 offen offset:3072 lds
s_lshl_b32 s74, s39, 4
s_sub_u32 s101, s101, s74
s_add_u32 m0, s101, 4240
s_add_u32 s100, s100, 4

buffer_load_dwordx4 v112, s[20:23], s100 offen offset:0 lds
buffer_load_dwordx4 v112, s[20:23], s100 offen offset:1024 lds
buffer_load_dwordx4 v112, s[20:23], s100 offen offset:2048 lds
buffer_load_dwordx4 v112, s[20:23], s100 offen offset:3072 lds
s_lshl_b32 s100, s32, 12
buffer_load_dword v11, v118, s[20:23], s100 offen
s_lshl_b32 s101, s39, 3
s_add_u32 s100, s100, s101
s_mul_i32 s101, s39, 8336
s_add_u32 s101, s101, s33
s_add_u32 m0, s101, 64

s_nop 0
buffer_load_dwordx4 v112, s[20:23], s100 offen offset:0 lds
buffer_load_dwordx4 v112, s[20:23], s100 offen offset:1024 lds
buffer_load_dwordx4 v112, s[20:23], s100 offen offset:2048 lds
buffer_load_dwordx4 v112, s[20:23], s100 offen offset:3072 lds
s_lshl_b32 s74, s39, 4
s_sub_u32 s101, s101, s74
s_add_u32 m0, s101, 4240
s_add_u32 s100, s100, 4

buffer_load_dwordx4 v112, s[20:23], s100 offen offset:0 lds
buffer_load_dwordx4 v112, s[20:23], s100 offen offset:1024 lds
buffer_load_dwordx4 v112, s[20:23], s100 offen offset:2048 lds
buffer_load_dwordx4 v112, s[20:23], s100 offen offset:3072 lds
s_add_u32 s84, s32, 2
s_add_u32 s85, s33, 51840

s_lshl_b32 s100, s84, 12
buffer_load_dword v253, v118, s[20:23], s100 offen
s_lshl_b32 s101, s39, 3
s_add_u32 s100, s100, s101
s_mul_i32 s101, s39, 8336
s_add_u32 s101, s101, s85
s_add_u32 m0, s101, 64

s_nop 0
buffer_load_dwordx4 v112, s[20:23], s100 offen offset:0 lds
buffer_load_dwordx4 v112, s[20:23], s100 offen offset:1024 lds
buffer_load_dwordx4 v112, s[20:23], s100 offen offset:2048 lds
buffer_load_dwordx4 v112, s[20:23], s100 offen offset:3072 lds
s_lshl_b32 s74, s39, 4
s_sub_u32 s101, s101, s74
s_add_u32 m0, s101, 4240
s_add_u32 s100, s100, 4

buffer_load_dwordx4 v112, s[20:23], s100 offen offset:0 lds
buffer_load_dwordx4 v112, s[20:23], s100 offen offset:1024 lds
buffer_load_dwordx4 v112, s[20:23], s100 offen offset:2048 lds
buffer_load_dwordx4 v112, s[20:23], s100 offen offset:3072 lds

s_barrier
buffer_load_dwordx4 v[192:195], v10, s[16:19], s87 offen offset:0
buffer_load_dwordx4 v[196:199], v10, s[16:19], s87 offen offset:16
buffer_load_dwordx4 v[200:203], v10, s[16:19], s87 offen offset:32
buffer_load_dwordx4 v[204:207], v10, s[16:19], s87 offen offset:48
buffer_load_dwordx4 v[20:23], v13, s[8:11], 0 offen offset:1280
buffer_load_dwordx4 v[24:27], v13, s[8:11], 0 offen offset:2560
buffer_load_dwordx4 v[28:31], v13, s[8:11], 0 offen offset:3840
buffer_load_dwordx4 v[32:35], v14, s[8:11], 0 offen offset:0
buffer_load_dwordx4 v[64:67], v14, s[12:15], 0 offen offset:0
buffer_load_dwordx4 v[36:39], v14, s[8:11], 0 offen offset:1280
buffer_load_dwordx4 v[68:71], v14, s[12:15], 0 offen offset:1280
buffer_load_dwordx4 v[40:43], v14, s[8:11], 0 offen offset:2560
buffer_load_dwordx4 v[72:75], v14, s[12:15], 0 offen offset:2560
buffer_load_dwordx4 v[44:47], v14, s[8:11], 0 offen offset:3840
buffer_load_dwordx4 v[76:79], v14, s[12:15], 0 offen offset:3840
buffer_load_dwordx4 v[48:51], v15, s[8:11], 0 offen offset:0
buffer_load_dwordx4 v[80:83], v15, s[12:15], 0 offen offset:0
buffer_load_dwordx4 v[52:55], v15, s[8:11], 0 offen offset:1280
buffer_load_dwordx4 v[84:87], v15, s[12:15], 0 offen offset:1280
buffer_load_dwordx4 v[56:59], v15, s[8:11], 0 offen offset:2560
buffer_load_dwordx4 v[88:91], v15, s[12:15], 0 offen offset:2560
buffer_load_dwordx4 v[60:63], v15, s[8:11], 0 offen offset:3840
buffer_load_dwordx4 v[92:95], v15, s[12:15], 0 offen offset:3840
buffer_load_dword v124, off, s[40:43], 0 sc1
L_pr_a1:
v_lshlrev_b32 v248, 12, v8
v_lshl_add_u32 v248, v9, 4, v248
s_mul_i32 s83, s98, 262272
s_sub_u32 s100, 1984, s99
s_lshl_b32 s100, s100, 1
s_add_u32 s83, s83, s100
s_add_u32 s83, s83, 2621440
s_lshl_b32 s100, s98, 13
s_lshl_b32 s101, s96, 8
s_add_u32 s100, s100, s101
s_add_u32 s95, s100, 17580032
v_sub_u32 v10, 7, v8
v_xor_b32 v10, v10, v9
v_lshlrev_b32 v10, 4, v10
v_lshlrev_b32 v251, 4, v9
s_mul_i32 s100, s39, 4640
s_add_u32 s100, s100, s33
s_add_u32 s100, s100, 16656
s_cmp_ge_u32 s3, 4
s_cbranch_scc1 L_pr_l0
v_lshl_add_u32 v249, v9, 10, v10
v_lshrrev_b32 v250, 2, v9
v_mul_u32_u24 v250, 99584, v250
v_add3_u32 v249, s100, v249, v250
v_lshlrev_b32 v250, 7, v8
v_add_u32 v250, s100, v250
s_branch L_pr_l1
L_pr_l0:
v_lshl_add_u32 v249, v9, 9, v10
v_add_u32 v249, s100, v249
v_lshrrev_b32 v10, 2, v8
v_bfe_u32 v250, v1, 3, 2
v_lshlrev_b32 v250, 7, v250
v_lshl_add_u32 v250, v10, 9, v250
v_add_u32 v250, s100, v250
v_lshlrev_b32 v10, 4, v10
v_xor_b32 v251, v251, v10
v_lshrrev_b32 v10, 5, v1
v_bfe_u32 v248, v1, 3, 2
v_lshl_add_u32 v248, v10, 3, v248
v_lshlrev_b32 v248, 12, v248
v_lshl_add_u32 v248, v9, 4, v248
L_pr_l1:
s_waitcnt vmcnt(20)
s_cmp_lt_u32 s3, 4
s_cbranch_scc1 L_pr_nh
v_add_u32 v4, s33, v116
v_subrev_u32 v5, 51840, v4
v_add_u32 v6, 51840, v4
ds_write_b32 v4, v11
ds_write_b32 v5, v252
ds_write_b32 v6, v253
s_lshl_b32 s100, s3, 2
s_add_u32 s100, s100, 163296
v_mov_b32 v4, s100
s_waitcnt lgkmcnt(0)
ds_write_b32 v4, v4
L_pr_nh:

v_lshlrev_b32 v128, 16, v192
v_lshlrev_b32 v129, 16, v194
v_and_b32 v130, 0xffff0000, v192
v_and_b32 v131, 0xffff0000, v194
v_lshlrev_b32 v132, 16, v193
v_lshlrev_b32 v133, 16, v195
v_and_b32 v134, 0xffff0000, v193
v_and_b32 v135, 0xffff0000, v195
v_lshlrev_b32 v136, 16, v196
v_lshlrev_b32 v137, 16, v198
v_and_b32 v138, 0xffff0000, v196
v_and_b32 v139, 0xffff0000, v198
v_lshlrev_b32 v140, 16, v197
v_lshlrev_b32 v141, 16, v199
v_and_b32 v142, 0xffff0000, v197
v_and_b32 v143, 0xffff0000, v199
v_lshlrev_b32 v144, 16, v200
v_lshlrev_b32 v145, 16, v202
v_and_b32 v146, 0xffff0000, v200
v_and_b32 v147, 0xffff0000, v202
v_lshlrev_b32 v148, 16, v201
v_lshlrev_b32 v149, 16, v203
v_and_b32 v150, 0xffff0000, v201
v_and_b32 v151, 0xffff0000, v203
v_lshlrev_b32 v152, 16, v204
v_lshlrev_b32 v153, 16, v206
v_and_b32 v154, 0xffff0000, v204
v_and_b32 v155, 0xffff0000, v206
v_lshlrev_b32 v156, 16, v205
v_lshlrev_b32 v157, 16, v207
v_and_b32 v158, 0xffff0000, v205
v_and_b32 v159, 0xffff0000, v207
s_waitcnt vmcnt(17)
v_lshlrev_b32 v168, 16, v20
v_and_b32 v169, 0xffff0000, v20
v_lshlrev_b32 v170, 16, v21
v_and_b32 v171, 0xffff0000, v21
v_lshlrev_b32 v172, 16, v22
v_and_b32 v173, 0xffff0000, v22
v_lshlrev_b32 v174, 16, v23
v_and_b32 v175, 0xffff0000, v23
v_lshlrev_b32 v176, 16, v24
v_and_b32 v177, 0xffff0000, v24
v_lshlrev_b32 v178, 16, v25
v_and_b32 v179, 0xffff0000, v25
v_lshlrev_b32 v180, 16, v26
v_and_b32 v181, 0xffff0000, v26
v_lshlrev_b32 v182, 16, v27
v_and_b32 v183, 0xffff0000, v27
v_lshlrev_b32 v184, 16, v28
v_and_b32 v185, 0xffff0000, v28
v_lshlrev_b32 v186, 16, v29
v_and_b32 v187, 0xffff0000, v29
v_lshlrev_b32 v188, 16, v30
v_and_b32 v189, 0xffff0000, v30
v_lshlrev_b32 v190, 16, v31
v_and_b32 v191, 0xffff0000, v31
s_waitcnt vmcnt(16)
v_lshlrev_b32 v160, 16, v32
v_and_b32 v161, 0xffff0000, v32
v_lshlrev_b32 v162, 16, v33
v_and_b32 v163, 0xffff0000, v33
v_lshlrev_b32 v164, 16, v34
v_and_b32 v165, 0xffff0000, v34
v_lshlrev_b32 v166, 16, v35
v_and_b32 v167, 0xffff0000, v35
v_pk_mul_f32 v[96:97], v[168:169], v[134:135]
v_pk_mul_f32 v[98:99], v[170:171], v[142:143]
v_pk_mul_f32 v[100:101], v[172:173], v[150:151]
v_pk_mul_f32 v[102:103], v[174:175], v[158:159]
v_pk_fma_f32 v[96:97], v[176:177], v[132:133], v[96:97]
v_pk_fma_f32 v[98:99], v[178:179], v[140:141], v[98:99]
v_pk_fma_f32 v[100:101], v[180:181], v[148:149], v[100:101]
v_pk_fma_f32 v[102:103], v[182:183], v[156:157], v[102:103]
v_pk_fma_f32 v[96:97], v[184:185], v[130:131], v[96:97]
v_pk_fma_f32 v[98:99], v[186:187], v[138:139], v[98:99]
v_pk_fma_f32 v[100:101], v[188:189], v[146:147], v[100:101]
v_pk_fma_f32 v[102:103], v[190:191], v[154:155], v[102:103]
v_pk_fma_f32 v[96:97], v[160:161], v[128:129], v[96:97]
v_pk_fma_f32 v[98:99], v[162:163], v[136:137], v[98:99]
v_pk_fma_f32 v[100:101], v[164:165], v[144:145], v[100:101]
v_pk_fma_f32 v[102:103], v[166:167], v[152:153], v[102:103]
s_waitcnt vmcnt(15)
v_lshlrev_b32 v120, 16, v64
v_and_b32 v121, 0xffff0000, v64
v_pk_mul_f32 v[96:97], v[96:97], v[120:121]
v_lshlrev_b32 v122, 16, v65
v_and_b32 v123, 0xffff0000, v65
v_pk_mul_f32 v[98:99], v[98:99], v[122:123]
v_lshlrev_b32 v120, 16, v66
v_and_b32 v121, 0xffff0000, v66
v_pk_mul_f32 v[100:101], v[100:101], v[120:121]
v_lshlrev_b32 v122, 16, v67
v_and_b32 v123, 0xffff0000, v67
v_pk_mul_f32 v[102:103], v[102:103], v[122:123]
s_waitcnt vmcnt(14)
v_lshlrev_b32 v168, 16, v36
v_and_b32 v169, 0xffff0000, v36
v_lshlrev_b32 v170, 16, v37
v_and_b32 v171, 0xffff0000, v37
v_lshlrev_b32 v172, 16, v38
v_and_b32 v173, 0xffff0000, v38
v_lshlrev_b32 v174, 16, v39
v_and_b32 v175, 0xffff0000, v39
v_pk_mul_f32 v[104:105], v[176:177], v[134:135]
v_pk_mul_f32 v[106:107], v[178:179], v[142:143]
v_pk_mul_f32 v[108:109], v[180:181], v[150:151]
v_pk_mul_f32 v[110:111], v[182:183], v[158:159]
v_pk_fma_f32 v[104:105], v[184:185], v[132:133], v[104:105]
v_pk_fma_f32 v[106:107], v[186:187], v[140:141], v[106:107]
v_pk_fma_f32 v[108:109], v[188:189], v[148:149], v[108:109]
v_pk_fma_f32 v[110:111], v[190:191], v[156:157], v[110:111]
v_pk_fma_f32 v[104:105], v[160:161], v[130:131], v[104:105]
v_pk_fma_f32 v[106:107], v[162:163], v[138:139], v[106:107]
v_pk_fma_f32 v[108:109], v[164:165], v[146:147], v[108:109]
v_pk_fma_f32 v[110:111], v[166:167], v[154:155], v[110:111]
v_pk_fma_f32 v[104:105], v[168:169], v[128:129], v[104:105]
v_pk_fma_f32 v[106:107], v[170:171], v[136:137], v[106:107]
v_pk_fma_f32 v[108:109], v[172:173], v[144:145], v[108:109]
v_pk_fma_f32 v[110:111], v[174:175], v[152:153], v[110:111]
s_waitcnt vmcnt(13)
v_lshlrev_b32 v120, 16, v68
v_and_b32 v121, 0xffff0000, v68
v_pk_mul_f32 v[104:105], v[104:105], v[120:121]
v_lshlrev_b32 v122, 16, v69
v_and_b32 v123, 0xffff0000, v69
v_pk_mul_f32 v[106:107], v[106:107], v[122:123]
v_lshlrev_b32 v120, 16, v70
v_and_b32 v121, 0xffff0000, v70
v_pk_mul_f32 v[108:109], v[108:109], v[120:121]
v_lshlrev_b32 v122, 16, v71
v_and_b32 v123, 0xffff0000, v71
v_pk_mul_f32 v[110:111], v[110:111], v[122:123]
v_cvt_pk_bf16_f32 v195, v104, v96
v_cvt_pk_bf16_f32 v199, v105, v97
v_cvt_pk_bf16_f32 v203, v106, v98
v_cvt_pk_bf16_f32 v207, v107, v99
v_cvt_pk_bf16_f32 v211, v108, v100
v_cvt_pk_bf16_f32 v215, v109, v101
v_cvt_pk_bf16_f32 v219, v110, v102
v_cvt_pk_bf16_f32 v223, v111, v103
s_waitcnt vmcnt(12)
v_lshlrev_b32 v176, 16, v40
v_and_b32 v177, 0xffff0000, v40
v_lshlrev_b32 v178, 16, v41
v_and_b32 v179, 0xffff0000, v41
v_lshlrev_b32 v180, 16, v42
v_and_b32 v181, 0xffff0000, v42
v_lshlrev_b32 v182, 16, v43
v_and_b32 v183, 0xffff0000, v43
v_pk_mul_f32 v[96:97], v[184:185], v[134:135]
v_pk_mul_f32 v[98:99], v[186:187], v[142:143]
v_pk_mul_f32 v[100:101], v[188:189], v[150:151]
v_pk_mul_f32 v[102:103], v[190:191], v[158:159]
v_pk_fma_f32 v[96:97], v[160:161], v[132:133], v[96:97]
v_pk_fma_f32 v[98:99], v[162:163], v[140:141], v[98:99]
v_pk_fma_f32 v[100:101], v[164:165], v[148:149], v[100:101]
v_pk_fma_f32 v[102:103], v[166:167], v[156:157], v[102:103]
v_pk_fma_f32 v[96:97], v[168:169], v[130:131], v[96:97]
v_pk_fma_f32 v[98:99], v[170:171], v[138:139], v[98:99]
v_pk_fma_f32 v[100:101], v[172:173], v[146:147], v[100:101]
v_pk_fma_f32 v[102:103], v[174:175], v[154:155], v[102:103]
v_pk_fma_f32 v[96:97], v[176:177], v[128:129], v[96:97]
v_pk_fma_f32 v[98:99], v[178:179], v[136:137], v[98:99]
v_pk_fma_f32 v[100:101], v[180:181], v[144:145], v[100:101]
v_pk_fma_f32 v[102:103], v[182:183], v[152:153], v[102:103]
s_waitcnt vmcnt(11)
v_lshlrev_b32 v120, 16, v72
v_and_b32 v121, 0xffff0000, v72
v_pk_mul_f32 v[96:97], v[96:97], v[120:121]
v_lshlrev_b32 v122, 16, v73
v_and_b32 v123, 0xffff0000, v73
v_pk_mul_f32 v[98:99], v[98:99], v[122:123]
v_lshlrev_b32 v120, 16, v74
v_and_b32 v121, 0xffff0000, v74
v_pk_mul_f32 v[100:101], v[100:101], v[120:121]
v_lshlrev_b32 v122, 16, v75
v_and_b32 v123, 0xffff0000, v75
v_pk_mul_f32 v[102:103], v[102:103], v[122:123]
s_waitcnt vmcnt(10)
v_lshlrev_b32 v184, 16, v44
v_and_b32 v185, 0xffff0000, v44
v_lshlrev_b32 v186, 16, v45
v_and_b32 v187, 0xffff0000, v45
v_lshlrev_b32 v188, 16, v46
v_and_b32 v189, 0xffff0000, v46
v_lshlrev_b32 v190, 16, v47
v_and_b32 v191, 0xffff0000, v47
v_pk_mul_f32 v[104:105], v[160:161], v[134:135]
v_pk_mul_f32 v[106:107], v[162:163], v[142:143]
v_pk_mul_f32 v[108:109], v[164:165], v[150:151]
v_pk_mul_f32 v[110:111], v[166:167], v[158:159]
v_pk_fma_f32 v[104:105], v[168:169], v[132:133], v[104:105]
v_pk_fma_f32 v[106:107], v[170:171], v[140:141], v[106:107]
v_pk_fma_f32 v[108:109], v[172:173], v[148:149], v[108:109]
v_pk_fma_f32 v[110:111], v[174:175], v[156:157], v[110:111]
v_pk_fma_f32 v[104:105], v[176:177], v[130:131], v[104:105]
v_pk_fma_f32 v[106:107], v[178:179], v[138:139], v[106:107]
v_pk_fma_f32 v[108:109], v[180:181], v[146:147], v[108:109]
v_pk_fma_f32 v[110:111], v[182:183], v[154:155], v[110:111]
v_pk_fma_f32 v[104:105], v[184:185], v[128:129], v[104:105]
v_pk_fma_f32 v[106:107], v[186:187], v[136:137], v[106:107]
v_pk_fma_f32 v[108:109], v[188:189], v[144:145], v[108:109]
v_pk_fma_f32 v[110:111], v[190:191], v[152:153], v[110:111]
s_waitcnt vmcnt(9)
v_lshlrev_b32 v120, 16, v76
v_and_b32 v121, 0xffff0000, v76
v_pk_mul_f32 v[104:105], v[104:105], v[120:121]
v_lshlrev_b32 v122, 16, v77
v_and_b32 v123, 0xffff0000, v77
v_pk_mul_f32 v[106:107], v[106:107], v[122:123]
v_lshlrev_b32 v120, 16, v78
v_and_b32 v121, 0xffff0000, v78
v_pk_mul_f32 v[108:109], v[108:109], v[120:121]
v_lshlrev_b32 v122, 16, v79
v_and_b32 v123, 0xffff0000, v79
v_pk_mul_f32 v[110:111], v[110:111], v[122:123]
v_cvt_pk_bf16_f32 v194, v104, v96
v_cvt_pk_bf16_f32 v198, v105, v97
v_cvt_pk_bf16_f32 v202, v106, v98
v_cvt_pk_bf16_f32 v206, v107, v99
v_cvt_pk_bf16_f32 v210, v108, v100
v_cvt_pk_bf16_f32 v214, v109, v101
v_cvt_pk_bf16_f32 v218, v110, v102
v_cvt_pk_bf16_f32 v222, v111, v103
s_waitcnt vmcnt(8)
v_lshlrev_b32 v160, 16, v48
v_and_b32 v161, 0xffff0000, v48
v_lshlrev_b32 v162, 16, v49
v_and_b32 v163, 0xffff0000, v49
v_lshlrev_b32 v164, 16, v50
v_and_b32 v165, 0xffff0000, v50
v_lshlrev_b32 v166, 16, v51
v_and_b32 v167, 0xffff0000, v51
v_pk_mul_f32 v[96:97], v[168:169], v[134:135]
v_pk_mul_f32 v[98:99], v[170:171], v[142:143]
v_pk_mul_f32 v[100:101], v[172:173], v[150:151]
v_pk_mul_f32 v[102:103], v[174:175], v[158:159]
v_pk_fma_f32 v[96:97], v[176:177], v[132:133], v[96:97]
v_pk_fma_f32 v[98:99], v[178:179], v[140:141], v[98:99]
v_pk_fma_f32 v[100:101], v[180:181], v[148:149], v[100:101]
v_pk_fma_f32 v[102:103], v[182:183], v[156:157], v[102:103]
v_pk_fma_f32 v[96:97], v[184:185], v[130:131], v[96:97]
v_pk_fma_f32 v[98:99], v[186:187], v[138:139], v[98:99]
v_pk_fma_f32 v[100:101], v[188:189], v[146:147], v[100:101]
v_pk_fma_f32 v[102:103], v[190:191], v[154:155], v[102:103]
v_pk_fma_f32 v[96:97], v[160:161], v[128:129], v[96:97]
v_pk_fma_f32 v[98:99], v[162:163], v[136:137], v[98:99]
v_pk_fma_f32 v[100:101], v[164:165], v[144:145], v[100:101]
v_pk_fma_f32 v[102:103], v[166:167], v[152:153], v[102:103]
s_waitcnt vmcnt(7)
v_lshlrev_b32 v120, 16, v80
v_and_b32 v121, 0xffff0000, v80
v_pk_mul_f32 v[96:97], v[96:97], v[120:121]
v_lshlrev_b32 v122, 16, v81
v_and_b32 v123, 0xffff0000, v81
v_pk_mul_f32 v[98:99], v[98:99], v[122:123]
v_lshlrev_b32 v120, 16, v82
v_and_b32 v121, 0xffff0000, v82
v_pk_mul_f32 v[100:101], v[100:101], v[120:121]
v_lshlrev_b32 v122, 16, v83
v_and_b32 v123, 0xffff0000, v83
v_pk_mul_f32 v[102:103], v[102:103], v[122:123]
s_waitcnt vmcnt(6)
v_lshlrev_b32 v168, 16, v52
v_and_b32 v169, 0xffff0000, v52
v_lshlrev_b32 v170, 16, v53
v_and_b32 v171, 0xffff0000, v53
v_lshlrev_b32 v172, 16, v54
v_and_b32 v173, 0xffff0000, v54
v_lshlrev_b32 v174, 16, v55
v_and_b32 v175, 0xffff0000, v55
v_pk_mul_f32 v[104:105], v[176:177], v[134:135]
v_pk_mul_f32 v[106:107], v[178:179], v[142:143]
v_pk_mul_f32 v[108:109], v[180:181], v[150:151]
v_pk_mul_f32 v[110:111], v[182:183], v[158:159]
v_pk_fma_f32 v[104:105], v[184:185], v[132:133], v[104:105]
v_pk_fma_f32 v[106:107], v[186:187], v[140:141], v[106:107]
v_pk_fma_f32 v[108:109], v[188:189], v[148:149], v[108:109]
v_pk_fma_f32 v[110:111], v[190:191], v[156:157], v[110:111]
v_pk_fma_f32 v[104:105], v[160:161], v[130:131], v[104:105]
v_pk_fma_f32 v[106:107], v[162:163], v[138:139], v[106:107]
v_pk_fma_f32 v[108:109], v[164:165], v[146:147], v[108:109]
v_pk_fma_f32 v[110:111], v[166:167], v[154:155], v[110:111]
v_pk_fma_f32 v[104:105], v[168:169], v[128:129], v[104:105]
v_pk_fma_f32 v[106:107], v[170:171], v[136:137], v[106:107]
v_pk_fma_f32 v[108:109], v[172:173], v[144:145], v[108:109]
v_pk_fma_f32 v[110:111], v[174:175], v[152:153], v[110:111]
s_waitcnt vmcnt(5)
v_lshlrev_b32 v120, 16, v84
v_and_b32 v121, 0xffff0000, v84
v_pk_mul_f32 v[104:105], v[104:105], v[120:121]
v_lshlrev_b32 v122, 16, v85
v_and_b32 v123, 0xffff0000, v85
v_pk_mul_f32 v[106:107], v[106:107], v[122:123]
v_lshlrev_b32 v120, 16, v86
v_and_b32 v121, 0xffff0000, v86
v_pk_mul_f32 v[108:109], v[108:109], v[120:121]
v_lshlrev_b32 v122, 16, v87
v_and_b32 v123, 0xffff0000, v87
v_pk_mul_f32 v[110:111], v[110:111], v[122:123]
v_cvt_pk_bf16_f32 v193, v104, v96
v_cvt_pk_bf16_f32 v197, v105, v97
v_cvt_pk_bf16_f32 v201, v106, v98
v_cvt_pk_bf16_f32 v205, v107, v99
v_cvt_pk_bf16_f32 v209, v108, v100
v_cvt_pk_bf16_f32 v213, v109, v101
v_cvt_pk_bf16_f32 v217, v110, v102
v_cvt_pk_bf16_f32 v221, v111, v103
s_waitcnt vmcnt(4)
v_lshlrev_b32 v176, 16, v56
v_and_b32 v177, 0xffff0000, v56
v_lshlrev_b32 v178, 16, v57
v_and_b32 v179, 0xffff0000, v57
v_lshlrev_b32 v180, 16, v58
v_and_b32 v181, 0xffff0000, v58
v_lshlrev_b32 v182, 16, v59
v_and_b32 v183, 0xffff0000, v59
v_pk_mul_f32 v[96:97], v[184:185], v[134:135]
v_pk_mul_f32 v[98:99], v[186:187], v[142:143]
v_pk_mul_f32 v[100:101], v[188:189], v[150:151]
v_pk_mul_f32 v[102:103], v[190:191], v[158:159]
v_pk_fma_f32 v[96:97], v[160:161], v[132:133], v[96:97]
v_pk_fma_f32 v[98:99], v[162:163], v[140:141], v[98:99]
v_pk_fma_f32 v[100:101], v[164:165], v[148:149], v[100:101]
v_pk_fma_f32 v[102:103], v[166:167], v[156:157], v[102:103]
v_pk_fma_f32 v[96:97], v[168:169], v[130:131], v[96:97]
v_pk_fma_f32 v[98:99], v[170:171], v[138:139], v[98:99]
v_pk_fma_f32 v[100:101], v[172:173], v[146:147], v[100:101]
v_pk_fma_f32 v[102:103], v[174:175], v[154:155], v[102:103]
v_pk_fma_f32 v[96:97], v[176:177], v[128:129], v[96:97]
v_pk_fma_f32 v[98:99], v[178:179], v[136:137], v[98:99]
v_pk_fma_f32 v[100:101], v[180:181], v[144:145], v[100:101]
v_pk_fma_f32 v[102:103], v[182:183], v[152:153], v[102:103]
s_waitcnt vmcnt(3)
v_lshlrev_b32 v120, 16, v88
v_and_b32 v121, 0xffff0000, v88
v_pk_mul_f32 v[96:97], v[96:97], v[120:121]
v_lshlrev_b32 v122, 16, v89
v_and_b32 v123, 0xffff0000, v89
v_pk_mul_f32 v[98:99], v[98:99], v[122:123]
v_lshlrev_b32 v120, 16, v90
v_and_b32 v121, 0xffff0000, v90
v_pk_mul_f32 v[100:101], v[100:101], v[120:121]
v_lshlrev_b32 v122, 16, v91
v_and_b32 v123, 0xffff0000, v91
v_pk_mul_f32 v[102:103], v[102:103], v[122:123]
s_waitcnt vmcnt(2)
v_lshlrev_b32 v184, 16, v60
v_and_b32 v185, 0xffff0000, v60
v_lshlrev_b32 v186, 16, v61
v_and_b32 v187, 0xffff0000, v61
v_lshlrev_b32 v188, 16, v62
v_and_b32 v189, 0xffff0000, v62
v_lshlrev_b32 v190, 16, v63
v_and_b32 v191, 0xffff0000, v63
v_pk_mul_f32 v[104:105], v[160:161], v[134:135]
v_pk_mul_f32 v[106:107], v[162:163], v[142:143]
v_pk_mul_f32 v[108:109], v[164:165], v[150:151]
v_pk_mul_f32 v[110:111], v[166:167], v[158:159]
v_pk_fma_f32 v[104:105], v[168:169], v[132:133], v[104:105]
v_pk_fma_f32 v[106:107], v[170:171], v[140:141], v[106:107]
v_pk_fma_f32 v[108:109], v[172:173], v[148:149], v[108:109]
v_pk_fma_f32 v[110:111], v[174:175], v[156:157], v[110:111]
v_pk_fma_f32 v[104:105], v[176:177], v[130:131], v[104:105]
v_pk_fma_f32 v[106:107], v[178:179], v[138:139], v[106:107]
v_pk_fma_f32 v[108:109], v[180:181], v[146:147], v[108:109]
v_pk_fma_f32 v[110:111], v[182:183], v[154:155], v[110:111]
v_pk_fma_f32 v[104:105], v[184:185], v[128:129], v[104:105]
v_pk_fma_f32 v[106:107], v[186:187], v[136:137], v[106:107]
v_pk_fma_f32 v[108:109], v[188:189], v[144:145], v[108:109]
v_pk_fma_f32 v[110:111], v[190:191], v[152:153], v[110:111]
s_waitcnt vmcnt(1)
v_lshlrev_b32 v120, 16, v92
v_and_b32 v121, 0xffff0000, v92
v_pk_mul_f32 v[104:105], v[104:105], v[120:121]
v_lshlrev_b32 v122, 16, v93
v_and_b32 v123, 0xffff0000, v93
v_pk_mul_f32 v[106:107], v[106:107], v[122:123]
v_lshlrev_b32 v120, 16, v94
v_and_b32 v121, 0xffff0000, v94
v_pk_mul_f32 v[108:109], v[108:109], v[120:121]
v_lshlrev_b32 v122, 16, v95
v_and_b32 v123, 0xffff0000, v95
v_pk_mul_f32 v[110:111], v[110:111], v[122:123]
v_cvt_pk_bf16_f32 v192, v104, v96
v_cvt_pk_bf16_f32 v196, v105, v97
v_cvt_pk_bf16_f32 v200, v106, v98
v_cvt_pk_bf16_f32 v204, v107, v99
v_cvt_pk_bf16_f32 v208, v108, v100
v_cvt_pk_bf16_f32 v212, v109, v101
v_cvt_pk_bf16_f32 v216, v110, v102
v_cvt_pk_bf16_f32 v220, v111, v103
s_cmp_ge_u32 s3, 4
s_cbranch_scc1 L_pr_l2

ds_write_b128 v249, v[192:195] offset:0
ds_write_b128 v249, v[196:199] offset:128
ds_write_b128 v249, v[200:203] offset:256
ds_write_b128 v249, v[204:207] offset:384
ds_write_b128 v249, v[208:211] offset:512
ds_write_b128 v249, v[212:215] offset:640
ds_write_b128 v249, v[216:219] offset:768
ds_write_b128 v249, v[220:223] offset:896
v_xor_b32 v16, 0, v251
v_add_u32 v16, v16, v250
v_xor_b32 v17, 16, v251
v_add_u32 v17, v17, v250
v_xor_b32 v18, 32, v251
v_add_u32 v18, v18, v250
v_xor_b32 v19, 48, v251
v_add_u32 v19, v19, v250
v_add_u32 v250, 103680, v250
v_xor_b32 v20, 64, v251
v_add_u32 v20, v20, v250
v_xor_b32 v21, 80, v251
v_add_u32 v21, v21, v250
v_xor_b32 v22, 96, v251
v_add_u32 v22, v22, v250
v_xor_b32 v23, 112, v251
v_add_u32 v23, v23, v250
s_waitcnt lgkmcnt(0)
ds_read_b128 v[64:67], v16 offset:0
ds_read_b128 v[68:71], v17 offset:1024
ds_read_b128 v[72:75], v18 offset:2048
ds_read_b128 v[76:79], v19 offset:3072
ds_read_b128 v[80:83], v20 offset:0
ds_read_b128 v[84:87], v21 offset:1024
ds_read_b128 v[88:91], v22 offset:2048
ds_read_b128 v[92:95], v23 offset:3072
s_waitcnt lgkmcnt(7)
buffer_store_dwordx4 v[64:67], v248, s[24:27], s83 offen sc1
s_add_u32 s83, s83, 32768
s_waitcnt lgkmcnt(6)
buffer_store_dwordx4 v[68:71], v248, s[24:27], s83 offen sc1
s_add_u32 s83, s83, 32768
s_waitcnt lgkmcnt(5)
buffer_store_dwordx4 v[72:75], v248, s[24:27], s83 offen sc1
s_add_u32 s83, s83, 32768
s_waitcnt lgkmcnt(4)
buffer_store_dwordx4 v[76:79], v248, s[24:27], s83 offen sc1
s_add_u32 s83, s83, 32768
s_waitcnt lgkmcnt(3)
buffer_store_dwordx4 v[80:83], v248, s[24:27], s83 offen sc1
s_add_u32 s83, s83, 32768
s_waitcnt lgkmcnt(2)
buffer_store_dwordx4 v[84:87], v248, s[24:27], s83 offen sc1
s_add_u32 s83, s83, 32768
s_waitcnt lgkmcnt(1)
buffer_store_dwordx4 v[88:91], v248, s[24:27], s83 offen sc1
s_add_u32 s83, s83, 32768
s_waitcnt lgkmcnt(0)
buffer_store_dwordx4 v[92:95], v248, s[24:27], s83 offen sc1
s_add_u32 s84, s32, 4
s_add_u32 s85, s33, 103680

s_barrier
s_branch L_pr_l3
L_pr_l2:
v_xor_b32 v16, 0, v251
v_add_u32 v16, v16, v250
v_xor_b32 v17, 32, v251
v_add_u32 v17, v17, v250
v_xor_b32 v18, 64, v251
v_add_u32 v18, v18, v250
v_xor_b32 v19, 96, v251
v_add_u32 v19, v19, v250
ds_write_b128 v249, v[192:195] offset:0
ds_write_b128 v249, v[196:199] offset:128
ds_write_b128 v249, v[200:203] offset:256
ds_write_b128 v249, v[204:207] offset:384
s_waitcnt lgkmcnt(0)
ds_read_b128 v[64:67], v16 offset:0
ds_read_b128 v[68:71], v17 offset:1024
ds_read_b128 v[72:75], v18 offset:2048
ds_read_b128 v[76:79], v19 offset:3072
s_waitcnt lgkmcnt(3)
s_add_u32 s100, s83, 0
buffer_store_dwordx4 v[64:67], v248, s[24:27], s100 offen sc1
s_waitcnt lgkmcnt(2)
s_add_u32 s100, s83, 65536
buffer_store_dwordx4 v[68:71], v248, s[24:27], s100 offen sc1
s_waitcnt lgkmcnt(1)
s_add_u32 s100, s83, 131072
buffer_store_dwordx4 v[72:75], v248, s[24:27], s100 offen sc1
s_waitcnt lgkmcnt(0)
s_add_u32 s100, s83, 196608
buffer_store_dwordx4 v[76:79], v248, s[24:27], s100 offen sc1
ds_write_b128 v249, v[208:211] offset:0
ds_write_b128 v249, v[212:215] offset:128
ds_write_b128 v249, v[216:219] offset:256
ds_write_b128 v249, v[220:223] offset:384
s_waitcnt lgkmcnt(0)
ds_read_b128 v[80:83], v16 offset:0
ds_read_b128 v[84:87], v17 offset:1024
ds_read_b128 v[88:91], v18 offset:2048
ds_read_b128 v[92:95], v19 offset:3072
s_waitcnt lgkmcnt(3)
s_add_u32 s100, s83, 16384
buffer_store_dwordx4 v[80:83], v248, s[24:27], s100 offen sc1
s_waitcnt lgkmcnt(2)
s_add_u32 s100, s83, 81920
buffer_store_dwordx4 v[84:87], v248, s[24:27], s100 offen sc1
s_waitcnt lgkmcnt(1)
s_add_u32 s100, s83, 147456
buffer_store_dwordx4 v[88:91], v248, s[24:27], s100 offen sc1
s_waitcnt lgkmcnt(0)
s_add_u32 s100, s83, 212992
buffer_store_dwordx4 v[92:95], v248, s[24:27], s100 offen sc1
L_pr_l3:
s_and_b32 s99, s3, 3
s_add_u32 s74, s99, 28
s_cmp_ge_u32 s3, 4
s_cselect_b32 s74, s99, s74

s_lshl_b32 s99, s61, 2
s_add_u32 s74, s74, s99
s_mul_i32 s91, s37, 54
s_add_u32 s91, s91, s74
s_mul_i32 s91, s91, 5120
s_add_u32 s91, s91, 18382848
s_lshl_b32 s92, s37, 8
s_add_u32 s92, s92, 17924096

v_add_u32 v16, s33, v119
v_mov_b32 v20, 0
v_mov_b32 v21, 0
v_mov_b32 v22, 0
v_mov_b32 v23, 0
ds_write_b128 v16, v[20:23]

s_lshr_b32 s100, s86, 6
s_add_u32 s101, s86, 5
s_lshr_b32 s101, s101, 6
s_lshl_b32 s82, s100, 13
s_add_u32 s82, s82, 17580032
s_cmp_lg_u32 s100, s101
s_cselect_b32 s94, -1, 0
v_lshlrev_b32 v17, 8, v1
s_waitcnt vmcnt(0)

v_readfirstlane_b32 s6, v124
s_cmp_lg_u32 s6, 0
s_cbranch_scc1 L_nond_17
s_mov_b32 s74, 8192
L_non_16:
buffer_load_dword v124, off, s[40:43], 0 sc1
s_waitcnt vmcnt(0)
v_readfirstlane_b32 s6, v124
s_sub_u32 s74, s74, 1
s_cmp_eq_u32 s74, 0
s_cbranch_scc1 L_nond_17
s_cmp_eq_u32 s6, 0
s_cbranch_scc1 L_non_16
L_nond_17:

v_mov_b32 v16, s6
s_mov_b64 exec, 1
buffer_store_dword v16, off, s[24:27], s95 sc1
s_mov_b64 exec, -1

v_mov_b32 v24, -1
v_mov_b32 v25, -1
v_mov_b32 v26, -1
v_mov_b32 v27, -1

s_lshl_b32 s100, s39, 11
s_lshl_b32 s101, s32, 12
s_add_u32 s100, s100, s101
s_add_u32 s100, s100, 7864320
buffer_store_dwordx4 v[24:27], v112, s[24:27], s100 offen sc1
buffer_store_dwordx4 v[24:27], v112, s[24:27], s100 offen offset:1024 sc1

s_cmp_ge_u32 s3, 4
s_cbranch_scc1 L_pr_zc1

s_lshl_b32 s100, s39, 11
s_lshl_b32 s101, s84, 12
s_add_u32 s100, s100, s101
s_add_u32 s100, s100, 7864320
buffer_store_dwordx4 v[24:27], v112, s[24:27], s100 offen sc1
buffer_store_dwordx4 v[24:27], v112, s[24:27], s100 offen offset:1024 sc1

L_pr_zc1:
s_mov_b32 s74, 8192
s_mov_b32 exec_hi, s94
L_kvp_18:
buffer_load_dword v16, v17, s[24:27], s82 offen sc1
s_waitcnt vmcnt(0)
v_cmp_ne_u32 vcc, s6, v16
s_cmp_eq_u64 vcc, 0
s_cbranch_scc1 L_kvd_19
s_mov_b64 exec, vcc
s_sleep 4
s_sub_u32 s74, s74, 1
s_cmp_lg_u32 s74, 0
s_cbranch_scc1 L_kvp_18
L_kvd_19:
s_mov_b64 exec, -1

s_lshl_b32 s100, s32, 12
s_lshr_b32 s101, s32, 6
s_lshl_b32 s101, s101, 6
s_add_u32 s101, s101, s39
s_lshl_b32 s101, s101, 1
s_add_u32 s100, s100, s101
s_add_u32 s100, s100, 2621440
s_mul_i32 s101, s39, 4640
s_add_u32 s101, s101, s33
s_add_u32 m0, s101, 16656

s_nop 0
buffer_load_dwordx4 v112, s[24:27], s100 offen offset:0 lds
buffer_load_dwordx4 v112, s[24:27], s100 offen offset:1024 lds
buffer_load_dwordx4 v112, s[24:27], s100 offen offset:2048 lds
buffer_load_dwordx4 v112, s[24:27], s100 offen offset:3072 lds
s_mul_i32 s100, s39, 2560
s_lshl_b32 s101, s32, 2
s_add_u32 s100, s100, s101
s_add_u32 s95, s100, 18055168

v_mov_b32 v16, s6
s_mov_b64 exec, 1
buffer_store_dword v16, off, s[24:27], s95 sc1
s_mov_b64 exec, -1

s_cmp_ge_u32 s3, 4
s_cbranch_scc1 L_pr_zf1
s_add_u32 s95, s95, 16

v_mov_b32 v16, s6
s_mov_b64 exec, 1
buffer_store_dword v16, off, s[24:27], s95 sc1
s_mov_b64 exec, -1

L_pr_zf1:
s_and_b32 s99, s3, 3
s_add_u32 s74, s99, 28
s_cmp_ge_u32 s3, 4
s_cselect_b32 s74, s99, s74
s_mov_b32 s88, 0x1111111
s_mov_b32 s89, 0
s_lshl_b64 s[88:89], s[88:89], s74
s_and_b32 s89, s89, 0x3fffff
s_mul_i32 s101, s36, 221184
s_add_u32 s101, s101, 10485760
s_lshl_b32 s100, s99, 10
s_add_u32 s55, s101, s100
s_lshl_b32 s100, s74, 10
s_add_u32 s101, s101, s100
s_lshl_b32 s100, s61, 12
s_add_u32 s101, s101, s100

s_add_u32 s100, s99, 1
s_and_b32 s100, s100, 3
s_mul_i32 s74, s100, 55296
s_add_u32 s44, s101, s74
s_add_u32 s50, s55, s74
s_mul_i32 s74, s100, 15360
s_add_u32 s74, s74, 98304
s_mul_i32 s100, s100, 5120
s_mul_i32 vcc_lo, s99, 24576
s_add_u32 s100, s100, vcc_lo
s_cmp_ge_u32 s3, 4
s_cselect_b32 s74, s100, s74
v_lshl_add_u32 v121, v1, 4, s74

s_add_u32 s100, s99, 2
s_and_b32 s100, s100, 3
s_mul_i32 s74, s100, 55296
s_add_u32 s45, s101, s74
s_add_u32 s51, s55, s74
s_mul_i32 s74, s100, 15360
s_add_u32 s74, s74, 103424
s_mul_i32 s100, s100, 5120
s_mul_i32 vcc_lo, s99, 24576
s_add_u32 s100, s100, vcc_lo
s_cmp_ge_u32 s3, 4
s_cselect_b32 s74, s100, s74
v_lshl_add_u32 v122, v1, 4, s74

s_add_u32 s100, s99, 3
s_and_b32 s100, s100, 3
s_mul_i32 s74, s100, 55296
s_add_u32 s46, s101, s74
s_add_u32 s52, s55, s74
s_mul_i32 s74, s100, 15360
s_add_u32 s74, s74, 108544
s_mul_i32 s100, s100, 5120
s_mul_i32 vcc_lo, s99, 24576
s_add_u32 s100, s100, vcc_lo
s_cmp_ge_u32 s3, 4
s_cselect_b32 s74, s100, s74
v_lshl_add_u32 v123, v1, 4, s74

s_add_u32 s100, s99, 4
s_and_b32 s100, s100, 3
s_mul_i32 s74, s100, 55296
s_add_u32 s47, s101, s74
s_add_u32 s53, s55, s74
s_mul_i32 s74, s100, 15360
s_add_u32 s74, s74, 113664
s_mul_i32 s100, s100, 5120
s_mul_i32 vcc_lo, s99, 24576
s_add_u32 s100, s100, vcc_lo
s_cmp_ge_u32 s3, 4
s_cselect_b32 s74, s100, s74
v_lshl_add_u32 v124, v1, 4, s74

s_and_b32 s100, s5, 3
s_lshl_b32 s100, s100, 1
s_add_u32 s100, s100, s37
s_sub_u32 s101, s100, 7
s_cmp_ge_u32 s100, 7
s_cselect_b32 s100, s101, s100
s_mul_i32 s55, s100, 1

s_lshl_b32 s87, s36, 6
s_lshl_b32 s100, s99, 4
s_add_u32 s87, s87, s100

s_mov_b32 s86, 0
s_mov_b32 s96, 0
s_mov_b32 s97, 1
s_mov_b32 s98, 193
s_cmp_ge_u32 s3, 4
s_cbranch_scc1 L_conv

s_lshl_b32 s100, s84, 12
s_lshr_b32 s101, s84, 6
s_lshl_b32 s101, s101, 6
s_add_u32 s101, s101, s39
s_lshl_b32 s101, s101, 1
s_add_u32 s100, s100, s101
s_add_u32 s100, s100, 2621440
s_mul_i32 s101, s39, 4640
s_add_u32 s101, s101, s85
s_add_u32 m0, s101, 16656

s_nop 0
buffer_load_dwordx4 v112, s[24:27], s100 offen offset:0 lds
buffer_load_dwordx4 v112, s[24:27], s100 offen offset:1024 lds
buffer_load_dwordx4 v112, s[24:27], s100 offen offset:2048 lds
buffer_load_dwordx4 v112, s[24:27], s100 offen offset:3072 lds
v_add_u32 v16, s85, v119
v_mov_b32 v20, 0
v_mov_b32 v21, 0
v_mov_b32 v22, 0
v_mov_b32 v23, 0
ds_write_b128 v16, v[20:23]

s_mov_b32 s97, 2
s_mov_b32 s98, 145
s_lshl_b32 s100, s3, 2
s_add_u32 s100, s100, 163312
v_mov_b32 v4, s100
s_mov_b32 s74, 8192
L_pr_fw:
ds_read_b32 v5, v4
s_waitcnt lgkmcnt(0)
v_readfirstlane_b32 s100, v5
s_cmp_lg_u32 s100, 0
s_cbranch_scc1 L_pr_fd
s_sleep 2
s_sub_u32 s74, s74, 1
s_cmp_lg_u32 s74, 0
s_cbranch_scc1 L_pr_fw
L_pr_fd:

L_conv:
v_add_u32 v7, s33, v113
v_add_u32 v8, s33, v114
v_add_u32 v9, s33, v115
v_add_u32 v10, s33, v116
v_add_u32 v13, s33, v112
v_add_u32 v14, s33, v117
s_bitcmp0_b32 s98, 0
s_cbranch_scc1 L_conv_nw
s_bitcmp1_b32 s98, 5
s_cbranch_scc1 L_conv_w8
s_bitcmp1_b32 s98, 2
s_cbranch_scc1 L_conv_wr
s_waitcnt vmcnt(0)
L_conv_wr:
s_waitcnt vmcnt(13)
L_conv_w8:
s_waitcnt vmcnt(22)
s_bitcmp1_b32 s98, 7
s_cbranch_scc1 L_conv_nh
ds_write_b32 v10, v11
L_conv_nh:
s_cmp_eq_u32 s39, 0
s_cbranch_scc1 L_conv_nw
s_add_u32 s100, s33, 25390
v_mov_b32 v4, s100
v_mov_b32 v5, 0
s_mov_b64 exec, 1
ds_write_b16 v4, v5
s_bitcmp0_b32 s98, 4
s_cbranch_scc1 L_conv_nf2
v_add_u32 v4, 103680, v4
ds_write_b16 v4, v5
L_conv_nf2:
s_mov_b64 exec, -1
L_conv_nw:
s_waitcnt lgkmcnt(0)

s_lshl_b32 s100, s96, 2
s_add_u32 s100, s100, 1
s_lshl_b32 s101, s39, 2
v_mov_b32 v4, s100
v_add_u32 v5, s101, v12
ds_write_b32 v5, v4

v_min_u32 v252, 53, v1
v_lshlrev_b32 v252, 2, v252
s_bitcmp0_b32 s98, 6
s_cbranch_scc1 L_conv_nwf
buffer_load_dword v11, v252, s[24:27], s92 offen sc1
L_conv_nwf:

s_lshl_b32 s100, s96, 2
s_add_u32 s100, s100, 1
s_lshl_b32 s101, s39, 2
s_xor_b32 s101, s101, 4
v_add_u32 v5, s101, v12
s_mov_b32 s99, 65536
L_pw_20:
ds_read_b32 v4, v5
s_waitcnt lgkmcnt(0)
v_readfirstlane_b32 s101, v4
s_cmp_ge_u32 s101, s100
s_cbranch_scc1 L_pwd_21
s_sub_u32 s99, s99, 1
s_cmp_lg_u32 s99, 0
s_cbranch_scc1 L_pw_20
L_pwd_21:

s_lshr_b32 s100, s32, 1
s_lshl_b32 s100, s100, 2
s_load_dword s38, s[58:59], s100

ds_read_b128 v[76:79], v7 offset:3584
ds_read_b128 v[80:83], v8 offset:3584
ds_read_b128 v[72:75], v7 offset:3072
ds_read_b128 v[84:87], v8 offset:3072
ds_read_b128 v[68:71], v7 offset:2560
ds_read_b128 v[88:91], v8 offset:2560
ds_read_b128 v[64:67], v7 offset:2048
ds_read_b128 v[92:95], v8 offset:2048
ds_read_b128 v[48:51], v7 offset:0
ds_read_b128 v[96:99], v8 offset:1536
ds_read_b128 v[108:111], v8 offset:0
ds_read_b128 v[52:55], v7 offset:512
ds_read_b128 v[56:59], v7 offset:1024
ds_read_b128 v[60:63], v7 offset:1536
ds_read_b128 v[100:103], v8 offset:1024
ds_read_b128 v[104:107], v8 offset:512
s_bitcmp0_b32 s98, 8
s_cbranch_scc1 L_conv_nep
s_and_b32 s101, s3, 3
s_lshl_b32 s101, s101, 2
s_add_u32 s100, s101, 163312
v_mov_b32 v4, s100
s_mov_b32 s74, 8192
L_epw_22:
ds_read_b32 v5, v4
s_waitcnt lgkmcnt(0)
v_readfirstlane_b32 s100, v5
s_cmp_lg_u32 s100, 0
s_cbranch_scc1 L_epd_23
s_sleep 1
s_sub_u32 s74, s74, 1
s_cmp_lg_u32 s74, 0
s_cbranch_scc1 L_epw_22
L_epd_23:

s_add_u32 s100, s101, 162176
v_mov_b32 v4, s100
s_waitcnt vmcnt(0)
ds_write_b32 v4, v4

L_conv_nep:
s_waitcnt lgkmcnt(14)
v_mfma_f32_16x16x32_bf16 v[44:47], v[80:83], v[76:79], 0
ds_read_b128 v[76:79], v7 offset:3648
s_waitcnt lgkmcnt(14)
v_mfma_f32_16x16x32_bf16 v[40:43], v[80:83], v[72:75], 0
s_waitcnt lgkmcnt(13)
v_mfma_f32_16x16x32_bf16 v[44:47], v[84:87], v[72:75], v[44:47]
ds_read_b128 v[72:75], v7 offset:3136
s_waitcnt lgkmcnt(13)
v_mfma_f32_16x16x32_bf16 v[36:39], v[80:83], v[68:71], 0
v_mfma_f32_16x16x32_bf16 v[40:43], v[84:87], v[68:71], v[40:43]
s_waitcnt lgkmcnt(12)
v_mfma_f32_16x16x32_bf16 v[44:47], v[88:91], v[68:71], v[44:47]
ds_read_b128 v[68:71], v7 offset:2624
s_waitcnt lgkmcnt(12)
v_mfma_f32_16x16x32_bf16 v[32:35], v[80:83], v[64:67], 0
v_mfma_f32_16x16x32_bf16 v[36:39], v[84:87], v[64:67], v[36:39]
v_mfma_f32_16x16x32_bf16 v[40:43], v[88:91], v[64:67], v[40:43]
s_waitcnt lgkmcnt(11)
v_mfma_f32_16x16x32_bf16 v[44:47], v[92:95], v[64:67], v[44:47]
ds_read_b128 v[64:67], v7 offset:2112
s_waitcnt lgkmcnt(10)
v_mfma_f32_16x16x32_bf16 v[32:35], v[96:99], v[48:51], v[32:35]
s_waitcnt lgkmcnt(9)
v_mfma_f32_16x16x32_bf16 v[44:47], v[108:111], v[48:51], v[44:47]
ds_read_b128 v[108:111], v8 offset:64
s_waitcnt lgkmcnt(9)
v_mfma_f32_16x16x32_bf16 v[36:39], v[96:99], v[52:55], v[36:39]
s_waitcnt lgkmcnt(8)
v_mfma_f32_16x16x32_bf16 v[40:43], v[96:99], v[56:59], v[40:43]
s_waitcnt lgkmcnt(7)
v_mfma_f32_16x16x32_bf16 v[44:47], v[96:99], v[60:63], v[44:47]
ds_read_b128 v[96:99], v8 offset:1600
s_waitcnt lgkmcnt(7)
v_mfma_f32_16x16x32_bf16 v[36:39], v[100:103], v[48:51], v[36:39]
v_mfma_f32_16x16x32_bf16 v[40:43], v[100:103], v[52:55], v[40:43]
v_mfma_f32_16x16x32_bf16 v[44:47], v[100:103], v[56:59], v[44:47]
ds_read_b128 v[100:103], v8 offset:1088
s_waitcnt lgkmcnt(7)
v_mfma_f32_16x16x32_bf16 v[40:43], v[104:107], v[48:51], v[40:43]
v_mfma_f32_16x16x32_bf16 v[44:47], v[104:107], v[52:55], v[44:47]
ds_read_b128 v[104:107], v8 offset:576
v_mfma_f32_16x16x32_bf16 v[16:19], v[80:83], v[48:51], 0
v_mfma_f32_16x16x32_bf16 v[20:23], v[80:83], v[52:55], 0
v_mfma_f32_16x16x32_bf16 v[24:27], v[80:83], v[56:59], 0
v_mfma_f32_16x16x32_bf16 v[28:31], v[80:83], v[60:63], 0
ds_read_b128 v[80:83], v8 offset:3648
v_mfma_f32_16x16x32_bf16 v[20:23], v[84:87], v[48:51], v[20:23]
v_mfma_f32_16x16x32_bf16 v[24:27], v[84:87], v[52:55], v[24:27]
v_mfma_f32_16x16x32_bf16 v[28:31], v[84:87], v[56:59], v[28:31]
v_mfma_f32_16x16x32_bf16 v[32:35], v[84:87], v[60:63], v[32:35]
ds_read_b128 v[84:87], v8 offset:3136
v_mfma_f32_16x16x32_bf16 v[24:27], v[88:91], v[48:51], v[24:27]
v_mfma_f32_16x16x32_bf16 v[28:31], v[88:91], v[52:55], v[28:31]
v_mfma_f32_16x16x32_bf16 v[32:35], v[88:91], v[56:59], v[32:35]
v_mfma_f32_16x16x32_bf16 v[36:39], v[88:91], v[60:63], v[36:39]
ds_read_b128 v[88:91], v8 offset:2624
v_mfma_f32_16x16x32_bf16 v[28:31], v[92:95], v[48:51], v[28:31]
ds_read_b128 v[48:51], v7 offset:64
v_mfma_f32_16x16x32_bf16 v[32:35], v[92:95], v[52:55], v[32:35]
ds_read_b128 v[52:55], v7 offset:576
v_mfma_f32_16x16x32_bf16 v[36:39], v[92:95], v[56:59], v[36:39]
ds_read_b128 v[56:59], v7 offset:1088
v_mfma_f32_16x16x32_bf16 v[40:43], v[92:95], v[60:63], v[40:43]
ds_read_b128 v[92:95], v8 offset:2112
ds_read_b128 v[60:63], v7 offset:1600
s_waitcnt lgkmcnt(7)
v_mfma_f32_16x16x32_bf16 v[44:47], v[80:83], v[76:79], v[44:47]
ds_read_b128 v[76:79], v7 offset:3712
v_mfma_f32_16x16x32_bf16 v[40:43], v[80:83], v[72:75], v[40:43]
s_waitcnt lgkmcnt(7)
v_mfma_f32_16x16x32_bf16 v[44:47], v[84:87], v[72:75], v[44:47]
ds_read_b128 v[72:75], v7 offset:3200
v_mfma_f32_16x16x32_bf16 v[36:39], v[80:83], v[68:71], v[36:39]
v_mfma_f32_16x16x32_bf16 v[40:43], v[84:87], v[68:71], v[40:43]
s_waitcnt lgkmcnt(7)
v_mfma_f32_16x16x32_bf16 v[44:47], v[88:91], v[68:71], v[44:47]
ds_read_b128 v[68:71], v7 offset:2688
v_mfma_f32_16x16x32_bf16 v[32:35], v[80:83], v[64:67], v[32:35]
v_mfma_f32_16x16x32_bf16 v[36:39], v[84:87], v[64:67], v[36:39]
v_mfma_f32_16x16x32_bf16 v[40:43], v[88:91], v[64:67], v[40:43]
s_waitcnt lgkmcnt(4)
v_mfma_f32_16x16x32_bf16 v[44:47], v[92:95], v[64:67], v[44:47]
ds_read_b128 v[64:67], v7 offset:2176
v_mfma_f32_16x16x32_bf16 v[32:35], v[96:99], v[48:51], v[32:35]
v_mfma_f32_16x16x32_bf16 v[44:47], v[108:111], v[48:51], v[44:47]
ds_read_b128 v[108:111], v8 offset:128
v_mfma_f32_16x16x32_bf16 v[36:39], v[96:99], v[52:55], v[36:39]
v_mfma_f32_16x16x32_bf16 v[40:43], v[96:99], v[56:59], v[40:43]
s_waitcnt lgkmcnt(5)
v_mfma_f32_16x16x32_bf16 v[44:47], v[96:99], v[60:63], v[44:47]
ds_read_b128 v[96:99], v8 offset:1664
v_mfma_f32_16x16x32_bf16 v[36:39], v[100:103], v[48:51], v[36:39]
v_mfma_f32_16x16x32_bf16 v[40:43], v[100:103], v[52:55], v[40:43]
v_mfma_f32_16x16x32_bf16 v[44:47], v[100:103], v[56:59], v[44:47]
ds_read_b128 v[100:103], v8 offset:1152
v_mfma_f32_16x16x32_bf16 v[40:43], v[104:107], v[48:51], v[40:43]
v_mfma_f32_16x16x32_bf16 v[44:47], v[104:107], v[52:55], v[44:47]
ds_read_b128 v[104:107], v8 offset:640
v_mfma_f32_16x16x32_bf16 v[16:19], v[80:83], v[48:51], v[16:19]
v_mfma_f32_16x16x32_bf16 v[20:23], v[80:83], v[52:55], v[20:23]
v_mfma_f32_16x16x32_bf16 v[24:27], v[80:83], v[56:59], v[24:27]
v_mfma_f32_16x16x32_bf16 v[28:31], v[80:83], v[60:63], v[28:31]
ds_read_b128 v[80:83], v8 offset:3712
v_mfma_f32_16x16x32_bf16 v[20:23], v[84:87], v[48:51], v[20:23]
v_mfma_f32_16x16x32_bf16 v[24:27], v[84:87], v[52:55], v[24:27]
v_mfma_f32_16x16x32_bf16 v[28:31], v[84:87], v[56:59], v[28:31]
v_mfma_f32_16x16x32_bf16 v[32:35], v[84:87], v[60:63], v[32:35]
ds_read_b128 v[84:87], v8 offset:3200
v_mfma_f32_16x16x32_bf16 v[24:27], v[88:91], v[48:51], v[24:27]
v_mfma_f32_16x16x32_bf16 v[28:31], v[88:91], v[52:55], v[28:31]
v_mfma_f32_16x16x32_bf16 v[32:35], v[88:91], v[56:59], v[32:35]
s_bitcmp0_b32 s98, 6
s_cbranch_scc1 L_conv_npf
s_mov_b32 s74, 8192
L_cwf_24:
s_waitcnt vmcnt(0)
v_cmp_ne_u32 vcc, s6, v11
s_cmp_eq_u64 vcc, 0
s_cbranch_scc1 L_cwfd_25
buffer_load_dword v11, v252, s[24:27], s92 offen sc1
s_sub_u32 s74, s74, 1
s_cmp_lg_u32 s74, 0
s_cbranch_scc1 L_cwf_24
L_cwfd_25:

L_conv_npf:
v_mfma_f32_16x16x32_bf16 v[36:39], v[88:91], v[60:63], v[36:39]
ds_read_b128 v[88:91], v8 offset:2688
s_bitcmp0_b32 s98, 6
s_cbranch_scc1 L_cw_26
buffer_load_dwordx4 v[128:131], v112, s[24:27], s91 offen offset:0
buffer_load_dwordx4 v[132:135], v112, s[24:27], s91 offen offset:1024
buffer_load_dwordx4 v[136:139], v112, s[24:27], s91 offen offset:2048
L_cw_26:
v_mfma_f32_16x16x32_bf16 v[28:31], v[92:95], v[48:51], v[28:31]
ds_read_b128 v[48:51], v7 offset:128
v_mfma_f32_16x16x32_bf16 v[32:35], v[92:95], v[52:55], v[32:35]
ds_read_b128 v[52:55], v7 offset:640
v_mfma_f32_16x16x32_bf16 v[36:39], v[92:95], v[56:59], v[36:39]
ds_read_b128 v[56:59], v7 offset:1152
v_mfma_f32_16x16x32_bf16 v[40:43], v[92:95], v[60:63], v[40:43]
ds_read_b128 v[92:95], v8 offset:2176
ds_read_b128 v[60:63], v7 offset:1664
s_bitcmp0_b32 s98, 6
s_cbranch_scc1 L_cw_27
buffer_load_dwordx4 v[140:143], v112, s[24:27], s91 offen offset:3072
s_add_u32 s91, s91, 4096
buffer_load_dwordx4 v[144:147], v112, s[24:27], s91 offen
s_cmp_eq_u32 s0, 0
s_cselect_b32 s99, s60, 16384
s_add_u32 s91, s91, s99
buffer_load_dwordx4 v[148:151], v112, s[24:27], s91 offen offset:0
L_cw_27:
s_waitcnt lgkmcnt(7)
v_mfma_f32_16x16x32_bf16 v[44:47], v[80:83], v[76:79], v[44:47]
ds_read_b128 v[76:79], v7 offset:3776
v_mfma_f32_16x16x32_bf16 v[40:43], v[80:83], v[72:75], v[40:43]
s_waitcnt lgkmcnt(7)
v_mfma_f32_16x16x32_bf16 v[44:47], v[84:87], v[72:75], v[44:47]
ds_read_b128 v[72:75], v7 offset:3264
v_mfma_f32_16x16x32_bf16 v[36:39], v[80:83], v[68:71], v[36:39]
s_bitcmp0_b32 s98, 6
s_cbranch_scc1 L_cw_28
buffer_load_dwordx4 v[152:155], v112, s[24:27], s91 offen offset:1024
buffer_load_dwordx4 v[156:159], v112, s[24:27], s91 offen offset:2048
buffer_load_dwordx4 v[160:163], v112, s[24:27], s91 offen offset:3072
L_cw_28:
v_mfma_f32_16x16x32_bf16 v[40:43], v[84:87], v[68:71], v[40:43]
s_waitcnt lgkmcnt(7)
v_mfma_f32_16x16x32_bf16 v[44:47], v[88:91], v[68:71], v[44:47]
ds_read_b128 v[68:71], v7 offset:2752
v_mfma_f32_16x16x32_bf16 v[32:35], v[80:83], v[64:67], v[32:35]
v_mfma_f32_16x16x32_bf16 v[36:39], v[84:87], v[64:67], v[36:39]
s_bitcmp0_b32 s98, 6
s_cbranch_scc1 L_cw_29
s_add_u32 s91, s91, 4096
buffer_load_dwordx4 v[164:167], v112, s[24:27], s91 offen
s_cmp_eq_u32 s0, 1
s_cselect_b32 s99, s60, 16384
s_add_u32 s91, s91, s99
buffer_load_dwordx4 v[168:171], v112, s[24:27], s91 offen offset:0
buffer_load_dwordx4 v[172:175], v112, s[24:27], s91 offen offset:1024
L_cw_29:
v_mfma_f32_16x16x32_bf16 v[40:43], v[88:91], v[64:67], v[40:43]
s_waitcnt lgkmcnt(4)
v_mfma_f32_16x16x32_bf16 v[44:47], v[92:95], v[64:67], v[44:47]
ds_read_b128 v[64:67], v7 offset:2240
v_mfma_f32_16x16x32_bf16 v[32:35], v[96:99], v[48:51], v[32:35]
v_mfma_f32_16x16x32_bf16 v[44:47], v[108:111], v[48:51], v[44:47]
ds_read_b128 v[108:111], v8 offset:192
s_bitcmp0_b32 s98, 6
s_cbranch_scc1 L_cw_30
buffer_load_dwordx4 v[176:179], v112, s[24:27], s91 offen offset:2048
buffer_load_dwordx4 v[180:183], v112, s[24:27], s91 offen offset:3072
s_add_u32 s91, s91, 4096
buffer_load_dwordx4 v[184:187], v112, s[24:27], s91 offen
s_cmp_eq_u32 s0, 2
s_cselect_b32 s99, s60, 16384
s_add_u32 s91, s91, s99
L_cw_30:
v_mfma_f32_16x16x32_bf16 v[36:39], v[96:99], v[52:55], v[36:39]
v_mfma_f32_16x16x32_bf16 v[40:43], v[96:99], v[56:59], v[40:43]
s_waitcnt lgkmcnt(5)
v_mfma_f32_16x16x32_bf16 v[44:47], v[96:99], v[60:63], v[44:47]
ds_read_b128 v[96:99], v8 offset:1728
v_mfma_f32_16x16x32_bf16 v[36:39], v[100:103], v[48:51], v[36:39]
s_bitcmp0_b32 s98, 6
s_cbranch_scc1 L_cw_31
buffer_load_dwordx4 v[188:191], v112, s[24:27], s91 offen offset:0
buffer_load_dwordx4 v[192:195], v112, s[24:27], s91 offen offset:1024
buffer_load_dwordx4 v[196:199], v112, s[24:27], s91 offen offset:2048
L_cw_31:
v_mfma_f32_16x16x32_bf16 v[40:43], v[100:103], v[52:55], v[40:43]
v_mfma_f32_16x16x32_bf16 v[44:47], v[100:103], v[56:59], v[44:47]
ds_read_b128 v[100:103], v8 offset:1216
v_mfma_f32_16x16x32_bf16 v[40:43], v[104:107], v[48:51], v[40:43]
v_mfma_f32_16x16x32_bf16 v[44:47], v[104:107], v[52:55], v[44:47]
ds_read_b128 v[104:107], v8 offset:704
s_bitcmp0_b32 s98, 6
s_cbranch_scc1 L_cw_32
buffer_load_dwordx4 v[200:203], v112, s[24:27], s91 offen offset:3072
s_add_u32 s91, s91, 4096
buffer_load_dwordx4 v[204:207], v112, s[24:27], s91 offen
s_cmp_eq_u32 s0, 3
s_cselect_b32 s99, s60, 16384
s_add_u32 s91, s91, s99
buffer_load_dwordx4 v[208:211], v112, s[24:27], s91 offen offset:0
L_cw_32:
v_mfma_f32_16x16x32_bf16 v[16:19], v[80:83], v[48:51], v[16:19]
v_mfma_f32_16x16x32_bf16 v[20:23], v[80:83], v[52:55], v[20:23]
v_mfma_f32_16x16x32_bf16 v[24:27], v[80:83], v[56:59], v[24:27]
v_mfma_f32_16x16x32_bf16 v[28:31], v[80:83], v[60:63], v[28:31]
ds_read_b128 v[80:83], v8 offset:3776
s_bitcmp0_b32 s98, 6
s_cbranch_scc1 L_cw_33
buffer_load_dwordx4 v[212:215], v112, s[24:27], s91 offen offset:1024
buffer_load_dwordx4 v[216:219], v112, s[24:27], s91 offen offset:2048
buffer_load_dwordx4 v[220:223], v112, s[24:27], s91 offen offset:3072
L_cw_33:
v_mfma_f32_16x16x32_bf16 v[20:23], v[84:87], v[48:51], v[20:23]
v_mfma_f32_16x16x32_bf16 v[24:27], v[84:87], v[52:55], v[24:27]
v_mfma_f32_16x16x32_bf16 v[28:31], v[84:87], v[56:59], v[28:31]
v_mfma_f32_16x16x32_bf16 v[32:35], v[84:87], v[60:63], v[32:35]
ds_read_b128 v[84:87], v8 offset:3264
s_bitcmp0_b32 s98, 6
s_cbranch_scc1 L_cw_34
s_add_u32 s91, s91, 4096
buffer_load_dwordx4 v[224:227], v112, s[24:27], s91 offen
s_cmp_eq_u32 s0, 4
s_cselect_b32 s99, s60, 16384
s_add_u32 s91, s91, s99
buffer_load_dwordx4 v[228:231], v112, s[24:27], s91 offen offset:0
buffer_load_dwordx4 v[232:235], v112, s[24:27], s91 offen offset:1024
L_cw_34:
v_mfma_f32_16x16x32_bf16 v[24:27], v[88:91], v[48:51], v[24:27]
v_mfma_f32_16x16x32_bf16 v[28:31], v[88:91], v[52:55], v[28:31]
v_mfma_f32_16x16x32_bf16 v[32:35], v[88:91], v[56:59], v[32:35]
v_mfma_f32_16x16x32_bf16 v[36:39], v[88:91], v[60:63], v[36:39]
ds_read_b128 v[88:91], v8 offset:2752
s_bitcmp0_b32 s98, 6
s_cbranch_scc1 L_cw_35
buffer_load_dwordx4 v[236:239], v112, s[24:27], s91 offen offset:2048
buffer_load_dwordx4 v[240:243], v112, s[24:27], s91 offen offset:3072
s_add_u32 s91, s91, 4096
buffer_load_dwordx4 v[244:247], v112, s[24:27], s91 offen
s_cmp_eq_u32 s0, 5
s_cselect_b32 s99, s60, 16384
s_add_u32 s91, s91, s99
L_cw_35:
v_mfma_f32_16x16x32_bf16 v[28:31], v[92:95], v[48:51], v[28:31]
ds_read_b128 v[48:51], v7 offset:192
v_mfma_f32_16x16x32_bf16 v[32:35], v[92:95], v[52:55], v[32:35]
ds_read_b128 v[52:55], v7 offset:704
v_mfma_f32_16x16x32_bf16 v[36:39], v[92:95], v[56:59], v[36:39]
ds_read_b128 v[56:59], v7 offset:1216
v_mfma_f32_16x16x32_bf16 v[40:43], v[92:95], v[60:63], v[40:43]
ds_read_b128 v[92:95], v8 offset:2240
ds_read_b128 v[60:63], v7 offset:1728
s_waitcnt lgkmcnt(7)
v_mfma_f32_16x16x32_bf16 v[44:47], v[80:83], v[76:79], v[44:47]
v_mfma_f32_16x16x32_bf16 v[40:43], v[80:83], v[72:75], v[40:43]
s_waitcnt lgkmcnt(6)
v_mfma_f32_16x16x32_bf16 v[44:47], v[84:87], v[72:75], v[44:47]
v_mfma_f32_16x16x32_bf16 v[36:39], v[80:83], v[68:71], v[36:39]
ds_read_b32 v72, v9 offset:1600
v_mfma_f32_16x16x32_bf16 v[40:43], v[84:87], v[68:71], v[40:43]
ds_read_b32 v73, v9 offset:1536
s_waitcnt lgkmcnt(7)
v_mfma_f32_16x16x32_bf16 v[44:47], v[88:91], v[68:71], v[44:47]
ds_read_b32 v74, v9 offset:1088
v_mfma_f32_16x16x32_bf16 v[32:35], v[80:83], v[64:67], v[32:35]
ds_read_b32 v75, v9 offset:1024
v_mfma_f32_16x16x32_bf16 v[36:39], v[84:87], v[64:67], v[36:39]
ds_read_b32 v76, v9 offset:576
v_mfma_f32_16x16x32_bf16 v[40:43], v[88:91], v[64:67], v[40:43]
ds_read_b32 v77, v9 offset:512
s_and_b32 s100, s3, 3
s_add_u32 s101, s100, 28
s_cmp_ge_u32 s3, 4
s_cselect_b32 s100, s100, s101
v_cmp_gt_u32 vcc, 7, v1
s_nop 1
v_cndmask_b32 v126, 0, v1, vcc
v_lshl_add_u32 v126, v126, 2, s100
v_cmp_gt_u32 vcc, 54, v126
v_mov_b32 v125, s100
s_nop 0
v_cndmask_b32 v126, v125, v126, vcc
v_lshlrev_b32 v126, 8, v126
s_lshr_b32 s100, s36, 1
s_lshl_b32 s100, s100, 14
s_add_u32 s100, s100, 17661952
buffer_load_dword v125, v126, s[24:27], s100 offen sc1

s_waitcnt lgkmcnt(7)
v_mfma_f32_16x16x32_bf16 v[44:47], v[92:95], v[64:67], v[44:47]
ds_read_b32 v78, v9 offset:64
v_mfma_f32_16x16x32_bf16 v[32:35], v[96:99], v[48:51], v[32:35]
ds_read_b32 v79, v9 offset:0
v_mfma_f32_16x16x32_bf16 v[44:47], v[108:111], v[48:51], v[44:47]
v_mfma_f32_16x16x32_bf16 v[36:39], v[96:99], v[52:55], v[36:39]
v_mfma_f32_16x16x32_bf16 v[40:43], v[96:99], v[56:59], v[40:43]
s_waitcnt lgkmcnt(8)
v_mfma_f32_16x16x32_bf16 v[44:47], v[96:99], v[60:63], v[44:47]
v_mfma_f32_16x16x32_bf16 v[36:39], v[100:103], v[48:51], v[36:39]
v_mfma_f32_16x16x32_bf16 v[40:43], v[100:103], v[52:55], v[40:43]
v_mfma_f32_16x16x32_bf16 v[44:47], v[100:103], v[56:59], v[44:47]
v_mfma_f32_16x16x32_bf16 v[40:43], v[104:107], v[48:51], v[40:43]
v_mfma_f32_16x16x32_bf16 v[44:47], v[104:107], v[52:55], v[44:47]
v_mfma_f32_16x16x32_bf16 v[16:19], v[80:83], v[48:51], v[16:19]
v_mfma_f32_16x16x32_bf16 v[20:23], v[80:83], v[52:55], v[20:23]
v_mfma_f32_16x16x32_bf16 v[24:27], v[80:83], v[56:59], v[24:27]
s_waitcnt lgkmcnt(0)
s_lshl_b32 s100, s96, 2
s_add_u32 s100, s100, 2
s_lshl_b32 s101, s39, 2
v_mov_b32 v4, s100
v_add_u32 v5, s101, v12
ds_write_b32 v5, v4

v_mfma_f32_16x16x32_bf16 v[28:31], v[80:83], v[60:63], v[28:31]
v_mfma_f32_16x16x32_bf16 v[20:23], v[84:87], v[48:51], v[20:23]
v_mfma_f32_16x16x32_bf16 v[24:27], v[84:87], v[52:55], v[24:27]
v_mfma_f32_16x16x32_bf16 v[28:31], v[84:87], v[56:59], v[28:31]
v_mfma_f32_16x16x32_bf16 v[32:35], v[84:87], v[60:63], v[32:35]
v_mfma_f32_16x16x32_bf16 v[24:27], v[88:91], v[48:51], v[24:27]
v_mfma_f32_16x16x32_bf16 v[28:31], v[88:91], v[52:55], v[28:31]
v_mfma_f32_16x16x32_bf16 v[32:35], v[88:91], v[56:59], v[32:35]
v_mfma_f32_16x16x32_bf16 v[36:39], v[88:91], v[60:63], v[36:39]
v_mfma_f32_16x16x32_bf16 v[28:31], v[92:95], v[48:51], v[28:31]
v_mfma_f32_16x16x32_bf16 v[32:35], v[92:95], v[52:55], v[32:35]
v_mfma_f32_16x16x32_bf16 v[36:39], v[92:95], v[56:59], v[36:39]
v_mfma_f32_16x16x32_bf16 v[40:43], v[92:95], v[60:63], v[40:43]
s_lshl_b32 s100, s96, 2
s_add_u32 s100, s100, 2
s_lshl_b32 s101, s39, 2
s_xor_b32 s101, s101, 4
v_add_u32 v5, s101, v12
s_mov_b32 s99, 65536
L_pw_36:
ds_read_b32 v4, v5
s_waitcnt lgkmcnt(0)
v_readfirstlane_b32 s101, v4
s_cmp_ge_u32 s101, s100
s_cbranch_scc1 L_pwd_37
s_sub_u32 s99, s99, 1
s_cmp_lg_u32 s99, 0
s_cbranch_scc1 L_pw_36
L_pwd_37:

s_bitcmp1_b32 s32, 0
s_cbranch_scc1 L_conv_odd
s_lshl_b32 s38, s38, 16
L_conv_odd:
s_and_b32 s38, s38, 0xffff0000

s_cmp_eq_u32 s39, 0
s_cbranch_scc1 L_conv_x0

ds_write_b128 v13, v[16:19] offset:4096
ds_write_b128 v13, v[20:23] offset:5120
ds_write_b128 v13, v[24:27] offset:6144
ds_write_b128 v13, v[28:31] offset:7168
v_mov_b32 v16, v32
v_mov_b32 v17, v33
v_mov_b32 v18, v34
v_mov_b32 v19, v35
v_mov_b32 v20, v36
v_mov_b32 v21, v37
v_mov_b32 v22, v38
v_mov_b32 v23, v39
v_mov_b32 v24, v40
v_mov_b32 v25, v41
v_mov_b32 v26, v42
v_mov_b32 v27, v43
v_mov_b32 v28, v44
v_mov_b32 v29, v45
v_mov_b32 v30, v46
v_mov_b32 v31, v47
s_branch L_conv_x1
L_conv_x0:
ds_write_b128 v13, v[32:35] offset:0
ds_write_b128 v13, v[36:39] offset:1024
ds_write_b128 v13, v[40:43] offset:2048
ds_write_b128 v13, v[44:47] offset:3072
L_conv_x1:
s_waitcnt lgkmcnt(0)
s_lshl_b32 s100, s96, 2
s_add_u32 s100, s100, 3
s_lshl_b32 s101, s39, 2
v_mov_b32 v4, s100
v_add_u32 v5, s101, v12
ds_write_b32 v5, v4

s_lshl_b32 s100, s96, 2
s_add_u32 s100, s100, 3
s_lshl_b32 s101, s39, 2
s_xor_b32 s101, s101, 4
v_add_u32 v5, s101, v12
s_mov_b32 s99, 65536
L_pw_38:
ds_read_b32 v4, v5
s_waitcnt lgkmcnt(0)
v_readfirstlane_b32 s101, v4
s_cmp_ge_u32 s101, s100
s_cbranch_scc1 L_pwd_39
s_sub_u32 s99, s99, 1
s_cmp_lg_u32 s99, 0
s_cbranch_scc1 L_pw_38
L_pwd_39:

s_xor_b32 s100, s39, 1
s_lshl_b32 s100, s100, 12
v_add_u32 v6, s100, v13

ds_read_b128 v[32:35], v6 offset:0
ds_read_b128 v[36:39], v6 offset:1024
ds_read_b128 v[40:43], v6 offset:2048
ds_read_b128 v[44:47], v6 offset:3072
s_waitcnt lgkmcnt(3)
v_and_b32 v4, 0xffff0000, v72
v_lshlrev_b32 v11, 16, v72
v_add_f32 v16, v16, v32
v_add_f32 v17, v17, v33
v_fmac_f32 v16, s38, v4
v_fmac_f32 v17, s38, v11
v_cvt_pk_bf16_f32 v72, v16, v17
ds_write_b32 v14, v72 offset:0

v_and_b32 v4, 0xffff0000, v73
v_lshlrev_b32 v11, 16, v73
v_add_f32 v18, v18, v34
v_add_f32 v19, v19, v35
v_fmac_f32 v18, s38, v4
v_fmac_f32 v19, s38, v11
v_cvt_pk_bf16_f32 v73, v18, v19
ds_write_b32 v14, v73 offset:64

s_waitcnt lgkmcnt(4)
v_and_b32 v4, 0xffff0000, v74
v_lshlrev_b32 v11, 16, v74
v_add_f32 v20, v20, v36
v_add_f32 v21, v21, v37
v_fmac_f32 v20, s38, v4
v_fmac_f32 v21, s38, v11
v_cvt_pk_bf16_f32 v74, v20, v21
ds_write_b32 v14, v74 offset:512

v_and_b32 v4, 0xffff0000, v75
v_lshlrev_b32 v11, 16, v75
v_add_f32 v22, v22, v38
v_add_f32 v23, v23, v39
v_fmac_f32 v22, s38, v4
v_fmac_f32 v23, s38, v11
v_cvt_pk_bf16_f32 v75, v22, v23
ds_write_b32 v14, v75 offset:576

s_waitcnt lgkmcnt(5)
v_and_b32 v4, 0xffff0000, v76
v_lshlrev_b32 v11, 16, v76
v_add_f32 v24, v24, v40
v_add_f32 v25, v25, v41
v_fmac_f32 v24, s38, v4
v_fmac_f32 v25, s38, v11
v_cvt_pk_bf16_f32 v76, v24, v25
ds_write_b32 v14, v76 offset:1024

v_and_b32 v4, 0xffff0000, v77
v_lshlrev_b32 v11, 16, v77
v_add_f32 v26, v26, v42
v_add_f32 v27, v27, v43
v_fmac_f32 v26, s38, v4
v_fmac_f32 v27, s38, v11
v_cvt_pk_bf16_f32 v77, v26, v27
ds_write_b32 v14, v77 offset:1088

s_waitcnt lgkmcnt(6)
v_and_b32 v4, 0xffff0000, v78
v_lshlrev_b32 v11, 16, v78
v_add_f32 v28, v28, v44
v_add_f32 v29, v29, v45
v_fmac_f32 v28, s38, v4
v_fmac_f32 v29, s38, v11
v_cvt_pk_bf16_f32 v78, v28, v29
ds_write_b32 v14, v78 offset:1536

v_and_b32 v4, 0xffff0000, v79
v_lshlrev_b32 v11, 16, v79
v_add_f32 v30, v30, v46
v_add_f32 v31, v31, v47
v_fmac_f32 v30, s38, v4
v_fmac_f32 v31, s38, v11
v_cvt_pk_bf16_f32 v79, v30, v31
ds_write_b32 v14, v79 offset:1600

s_lshl_b32 s100, s39, 11
s_lshl_b32 s74, s32, 12
s_add_u32 s74, s74, s100
s_add_u32 s74, s74, 7864320
s_add_u32 s100, s100, 8192
v_add_u32 v6, s100, v13
s_waitcnt lgkmcnt(0)
ds_read_b128 v[16:19], v6
ds_read_b128 v[20:23], v6 offset:1024
s_mul_i32 s100, s39, 2560
s_lshl_b32 s101, s32, 2
s_add_u32 s100, s100, s101
s_add_u32 s90, s100, 18055168

s_waitcnt vmcnt(0)
v_cmp_ne_u32 vcc, s6, v125
s_cmp_eq_u64 vcc, 0
s_cselect_b32 s86, 1, 0

s_waitcnt lgkmcnt(0)
buffer_store_dwordx4 v[16:19], v112, s[24:27], s74 offen sc1
buffer_store_dwordx4 v[20:23], v112, s[24:27], s74 offen offset:1024 sc1

s_add_u32 s100, s96, 1
s_cmp_ge_u32 s100, s97
s_cbranch_scc1 L_conv_done
s_mov_b32 s96, s100
s_add_u32 s32, s32, 4
s_add_u32 s33, s33, 103680
s_mov_b32 s98, 64

s_branch L_conv
L_conv_done:

s_lshl_b32 s101, s39, 2
v_mov_b32 v4, 1000
v_add_u32 v5, s101, v12
ds_write_b32 v5, v4

L_g2_lentry:
s_cmp_ge_u32 s3, 4
s_cbranch_scc1 L_g2_go

s_mov_b32 s8, s48
s_mov_b32 s9, s49
s_mov_b32 s10, 2621440
s_mov_b32 s11, 0x00020000
s_mov_b32 s16, s68
s_mov_b32 s17, s69
s_mov_b32 s18, 2621440
s_mov_b32 s19, 0x00020000
s_and_b32 s99, s3, 3
s_mul_i32 s100, s37, 160
v_lshlrev_b32 v112, 4, v1
v_add_u32 v16, s87, v2
v_mul_u32_u24 v113, 1280, v16
v_lshl_add_u32 v113, v3, 4, v113
v_add_u32 v113, s100, v113
v_lshrrev_b32 v16, 2, v2
v_lshl_add_u32 v16, v3, 3, v16
v_and_b32 v17, 3, v2
v_lshlrev_b32 v17, 3, v17
s_mul_i32 s101, s99, 24576
s_add_u32 s101, s101, 20480
v_lshl_add_u32 v114, v16, 5, v17
v_add_u32 v114, s101, v114

v_add_u32 v120, s87, v2
v_lshlrev_b32 v120, 3, v120
s_mov_b32 s100, 17563648
buffer_load_dwordx2 v[118:119], v120, s[24:27], s100 offen sc1

v_lshlrev_b32 v14, 3, v3
v_sub_u32 v14, v113, v14
buffer_load_dwordx4 v[4:7], v113, s[8:11], 0 offen offset:0
buffer_load_dwordx4 v[8:11], v113, s[8:11], 0 offen offset:64
buffer_load_dwordx2 v[12:13], v14, s[8:11], 0 offen offset:128
v_mov_b32 v24, 163264
s_mov_b32 s74, 65536
L_xw_40:
ds_read_b128 v[16:19], v24
ds_read_b128 v[20:23], v24 offset:16
s_waitcnt lgkmcnt(0)
v_min_u32 v16, v16, v17
v_min3_u32 v16, v16, v18, v19
v_min3_u32 v16, v16, v20, v21
v_min3_u32 v16, v16, v22, v23
s_nop 0
v_readfirstlane_b32 s100, v16
s_cmp_ge_u32 s100, 1000
s_cbranch_scc1 L_xwd_41
s_sleep 1
s_sub_u32 s74, s74, 1
s_cmp_lg_u32 s74, 0
s_cbranch_scc1 L_xw_40
L_xwd_41:

L_g2_go:
s_lshr_b32 s96, s36, 1
s_lshl_b32 s96, s96, 14
s_add_u32 s96, s96, 17661952
s_ff1_i32_b64 s100, s[88:89]
v_cmp_gt_u32 vcc, 7, v1
s_nop 1
v_cndmask_b32 v14, 0, v1, vcc
v_lshl_add_u32 v14, v14, 2, s100
v_cmp_gt_u32 vcc, 54, v14
v_mov_b32 v15, s100
s_nop 0
v_cndmask_b32 v14, v15, v14, vcc
v_lshlrev_b32 v14, 8, v14
s_mov_b32 s90, 0
s_cmp_lg_u32 s86, 0
s_cbranch_scc1 L_hpd_43

L_g2_go3:
s_mov_b32 s74, 8192
L_hp_42:
buffer_load_dword v115, v14, s[24:27], s96 offen sc1
s_waitcnt vmcnt(0)
v_cmp_ne_u32 vcc, s6, v115
s_cmp_eq_u64 vcc, 0
s_cbranch_scc1 L_hpd_43
s_sub_u32 s74, s74, 1
s_cmp_lg_u32 s74, 0
s_cbranch_scc1 L_hp_42
L_hpd_43:

buffer_load_dwordx4 v[96:99], v112, s[24:27], s44 offen
s_cmp_eq_u32 s0, 0
s_cselect_b32 s56, s1, 4096
s_add_u32 s44, s44, s56
buffer_load_dwordx4 v[100:103], v112, s[24:27], s45 offen
s_add_u32 s45, s45, s56
buffer_load_dwordx4 v[104:107], v112, s[24:27], s46 offen
s_add_u32 s46, s46, s56
buffer_load_dwordx4 v[108:111], v112, s[24:27], s47 offen
s_add_u32 s47, s47, s56
buffer_load_dwordx4 v[248:251], v112, s[24:27], s44 offen
s_cmp_eq_u32 s0, 1
s_cselect_b32 s56, s1, 4096
s_add_u32 s44, s44, s56
buffer_load_dwordx4 v[252:255], v112, s[24:27], s45 offen
s_add_u32 s45, s45, s56
L_g2_e:
s_lshr_b32 s96, s36, 4
s_mul_i32 s96, s96, 2560
s_mul_i32 s97, s37, 320
s_add_u32 s96, s96, s97
s_add_u32 s96, s96, 18055168
v_lshlrev_b32 v15, 2, v1
v_min_u32 v14, 15, v1
v_add_u32 v14, 64, v14
v_lshlrev_b32 v125, 2, v14
s_mul_i32 s98, s3, 24576

s_waitcnt vmcnt(5)
v_mfma_f32_16x16x32_bf16 v[16:19], v[128:131], v[96:99], 0
v_mfma_f32_16x16x32_bf16 v[20:23], v[132:135], v[96:99], 0
v_mfma_f32_16x16x32_bf16 v[24:27], v[136:139], v[96:99], 0
v_mfma_f32_16x16x32_bf16 v[28:31], v[140:143], v[96:99], 0
v_mfma_f32_16x16x32_bf16 v[32:35], v[144:147], v[96:99], 0
buffer_load_dwordx4 v[96:99], v112, s[24:27], s46 offen
s_add_u32 s46, s46, s56
s_waitcnt vmcnt(5)
v_mfma_f32_16x16x32_bf16 v[36:39], v[128:131], v[100:103], 0
v_mfma_f32_16x16x32_bf16 v[40:43], v[132:135], v[100:103], 0
v_mfma_f32_16x16x32_bf16 v[44:47], v[136:139], v[100:103], 0
v_mfma_f32_16x16x32_bf16 v[48:51], v[140:143], v[100:103], 0
v_mfma_f32_16x16x32_bf16 v[52:55], v[144:147], v[100:103], 0
buffer_load_dwordx4 v[100:103], v112, s[24:27], s47 offen
s_add_u32 s47, s47, s56
s_waitcnt vmcnt(5)
v_mfma_f32_16x16x32_bf16 v[56:59], v[128:131], v[104:107], 0
v_mfma_f32_16x16x32_bf16 v[60:63], v[132:135], v[104:107], 0
v_mfma_f32_16x16x32_bf16 v[64:67], v[136:139], v[104:107], 0
v_mfma_f32_16x16x32_bf16 v[68:71], v[140:143], v[104:107], 0
v_mfma_f32_16x16x32_bf16 v[72:75], v[144:147], v[104:107], 0
buffer_load_dwordx4 v[104:107], v112, s[24:27], s44 offen
s_cmp_eq_u32 s0, 2
s_cselect_b32 s56, s1, 4096
s_add_u32 s44, s44, s56
s_waitcnt vmcnt(5)
v_mfma_f32_16x16x32_bf16 v[76:79], v[128:131], v[108:111], 0
buffer_load_dwordx4 v[128:131], v112, s[24:27], s45 offen
s_add_u32 s45, s45, s56
v_mfma_f32_16x16x32_bf16 v[80:83], v[132:135], v[108:111], 0
buffer_load_dwordx4 v[132:135], v112, s[24:27], s46 offen
s_add_u32 s46, s46, s56
v_mfma_f32_16x16x32_bf16 v[84:87], v[136:139], v[108:111], 0
buffer_load_dwordx4 v[136:139], v112, s[24:27], s47 offen
s_add_u32 s47, s47, s56
v_mfma_f32_16x16x32_bf16 v[88:91], v[140:143], v[108:111], 0
buffer_load_dwordx4 v[140:143], v112, s[24:27], s44 offen
s_cmp_eq_u32 s0, 3
s_cselect_b32 s56, s1, 4096
s_add_u32 s44, s44, s56
v_mfma_f32_16x16x32_bf16 v[92:95], v[144:147], v[108:111], 0
buffer_load_dwordx4 v[144:147], v112, s[24:27], s45 offen
s_add_u32 s45, s45, s56
buffer_load_dwordx4 v[108:111], v112, s[24:27], s46 offen
s_add_u32 s46, s46, s56
s_waitcnt vmcnt(10)
v_mfma_f32_16x16x32_bf16 v[16:19], v[148:151], v[248:251], v[16:19]
v_mfma_f32_16x16x32_bf16 v[20:23], v[152:155], v[248:251], v[20:23]
v_mfma_f32_16x16x32_bf16 v[24:27], v[156:159], v[248:251], v[24:27]
v_mfma_f32_16x16x32_bf16 v[28:31], v[160:163], v[248:251], v[28:31]
v_mfma_f32_16x16x32_bf16 v[32:35], v[164:167], v[248:251], v[32:35]
buffer_load_dwordx4 v[248:251], v112, s[24:27], s47 offen
s_add_u32 s47, s47, s56
s_waitcnt vmcnt(10)
v_mfma_f32_16x16x32_bf16 v[36:39], v[148:151], v[252:255], v[36:39]
v_mfma_f32_16x16x32_bf16 v[40:43], v[152:155], v[252:255], v[40:43]
v_mfma_f32_16x16x32_bf16 v[44:47], v[156:159], v[252:255], v[44:47]
v_mfma_f32_16x16x32_bf16 v[48:51], v[160:163], v[252:255], v[48:51]
v_mfma_f32_16x16x32_bf16 v[52:55], v[164:167], v[252:255], v[52:55]
buffer_load_dwordx4 v[252:255], v112, s[24:27], s44 offen
s_cmp_eq_u32 s0, 4
s_cselect_b32 s56, s1, 4096
s_add_u32 s44, s44, s56
s_waitcnt vmcnt(10)
v_mfma_f32_16x16x32_bf16 v[56:59], v[148:151], v[96:99], v[56:59]
v_mfma_f32_16x16x32_bf16 v[60:63], v[152:155], v[96:99], v[60:63]
v_mfma_f32_16x16x32_bf16 v[64:67], v[156:159], v[96:99], v[64:67]
v_mfma_f32_16x16x32_bf16 v[68:71], v[160:163], v[96:99], v[68:71]
v_mfma_f32_16x16x32_bf16 v[72:75], v[164:167], v[96:99], v[72:75]
buffer_load_dwordx4 v[96:99], v112, s[24:27], s45 offen
s_add_u32 s45, s45, s56
s_waitcnt vmcnt(10)
v_mfma_f32_16x16x32_bf16 v[76:79], v[148:151], v[100:103], v[76:79]
buffer_load_dwordx4 v[148:151], v112, s[24:27], s46 offen
s_add_u32 s46, s46, s56
v_mfma_f32_16x16x32_bf16 v[80:83], v[152:155], v[100:103], v[80:83]
buffer_load_dwordx4 v[152:155], v112, s[24:27], s47 offen
s_add_u32 s47, s47, s56
v_mfma_f32_16x16x32_bf16 v[84:87], v[156:159], v[100:103], v[84:87]
buffer_load_dword v116, v15, s[24:27], s96 offen sc1
buffer_load_dword v117, v125, s[24:27], s96 offen sc1
buffer_load_dwordx4 v[156:159], v112, s[24:27], s44 offen
s_cmp_eq_u32 s0, 5
s_cselect_b32 s56, s1, 4096
s_add_u32 s44, s44, s56
v_mfma_f32_16x16x32_bf16 v[88:91], v[160:163], v[100:103], v[88:91]
buffer_load_dwordx4 v[160:163], v112, s[24:27], s45 offen
s_add_u32 s45, s45, s56
v_mfma_f32_16x16x32_bf16 v[92:95], v[164:167], v[100:103], v[92:95]
s_waitcnt vmcnt(15)
v_mfma_f32_16x16x32_bf16 v[16:19], v[168:171], v[104:107], v[16:19]
v_mfma_f32_16x16x32_bf16 v[20:23], v[172:175], v[104:107], v[20:23]
v_mfma_f32_16x16x32_bf16 v[24:27], v[176:179], v[104:107], v[24:27]
v_mfma_f32_16x16x32_bf16 v[28:31], v[180:183], v[104:107], v[28:31]
v_mfma_f32_16x16x32_bf16 v[32:35], v[184:187], v[104:107], v[32:35]
buffer_load_dwordx4 v[164:167], v112, s[24:27], s46 offen
s_add_u32 s46, s46, s56
s_waitcnt vmcnt(15)
v_mfma_f32_16x16x32_bf16 v[36:39], v[168:171], v[128:131], v[36:39]
v_mfma_f32_16x16x32_bf16 v[40:43], v[172:175], v[128:131], v[40:43]
v_mfma_f32_16x16x32_bf16 v[44:47], v[176:179], v[128:131], v[44:47]
v_mfma_f32_16x16x32_bf16 v[48:51], v[180:183], v[128:131], v[48:51]
v_mfma_f32_16x16x32_bf16 v[52:55], v[184:187], v[128:131], v[52:55]
buffer_load_dwordx4 v[100:103], v112, s[24:27], s47 offen
s_add_u32 s47, s47, s56
s_waitcnt vmcnt(15)
v_mfma_f32_16x16x32_bf16 v[56:59], v[168:171], v[132:135], v[56:59]
v_mfma_f32_16x16x32_bf16 v[60:63], v[172:175], v[132:135], v[60:63]
v_mfma_f32_16x16x32_bf16 v[64:67], v[176:179], v[132:135], v[64:67]
v_mfma_f32_16x16x32_bf16 v[68:71], v[180:183], v[132:135], v[68:71]
v_mfma_f32_16x16x32_bf16 v[72:75], v[184:187], v[132:135], v[72:75]
s_and_b32 s100, s3, 6
s_cmp_eq_u32 s100, 2
s_cselect_b32 s91, 0x40000000, s91
s_cselect_b32 s44, 0x40000000, s44
s_cselect_b32 s45, 0x40000000, s45
s_cselect_b32 s46, 0x40000000, s46
s_cselect_b32 s47, 0x40000000, s47

s_cmp_eq_u32 s93, 0
s_cbranch_scc1 L_w7g_44
v_add_u32 v115, s93, v112
s_mov_b32 s91, 0x40000000
ds_read_b128 v[104:107], v115 offset:0
buffer_load_dword v126, v112, s[24:27], s91 offen
s_branch L_w7e_45
L_w7g_44:
buffer_load_dwordx4 v[104:107], v112, s[24:27], s91 offen offset:0
L_w7e_45:
s_waitcnt vmcnt(15)
v_mfma_f32_16x16x32_bf16 v[76:79], v[168:171], v[136:139], v[76:79]
s_cmp_eq_u32 s93, 0
s_cbranch_scc1 L_w7g_46
ds_read_b128 v[128:131], v115 offset:1024
buffer_load_dword v126, v112, s[24:27], s91 offen
s_branch L_w7e_47
L_w7g_46:
buffer_load_dwordx4 v[128:131], v112, s[24:27], s91 offen offset:1024
L_w7e_47:
v_mfma_f32_16x16x32_bf16 v[80:83], v[172:175], v[136:139], v[80:83]
v_mfma_f32_16x16x32_bf16 v[84:87], v[176:179], v[136:139], v[84:87]
v_mfma_f32_16x16x32_bf16 v[88:91], v[180:183], v[136:139], v[88:91]
v_mfma_f32_16x16x32_bf16 v[92:95], v[184:187], v[136:139], v[92:95]
s_waitcnt vmcnt(15)
v_mfma_f32_16x16x32_bf16 v[16:19], v[188:191], v[140:143], v[16:19]
v_mfma_f32_16x16x32_bf16 v[20:23], v[192:195], v[140:143], v[20:23]
v_mfma_f32_16x16x32_bf16 v[24:27], v[196:199], v[140:143], v[24:27]
v_mfma_f32_16x16x32_bf16 v[28:31], v[200:203], v[140:143], v[28:31]
v_mfma_f32_16x16x32_bf16 v[32:35], v[204:207], v[140:143], v[32:35]
s_cmp_eq_u32 s93, 0
s_cbranch_scc1 L_w7g_48
ds_read_b128 v[132:135], v115 offset:2048
buffer_load_dword v126, v112, s[24:27], s91 offen
s_branch L_w7e_49
L_w7g_48:
buffer_load_dwordx4 v[132:135], v112, s[24:27], s91 offen offset:2048
L_w7e_49:
s_waitcnt vmcnt(15)
v_mfma_f32_16x16x32_bf16 v[36:39], v[188:191], v[144:147], v[36:39]
v_mfma_f32_16x16x32_bf16 v[40:43], v[192:195], v[144:147], v[40:43]
v_mfma_f32_16x16x32_bf16 v[44:47], v[196:199], v[144:147], v[44:47]
v_mfma_f32_16x16x32_bf16 v[48:51], v[200:203], v[144:147], v[48:51]
v_mfma_f32_16x16x32_bf16 v[52:55], v[204:207], v[144:147], v[52:55]
s_cmp_eq_u32 s93, 0
s_cbranch_scc1 L_w7g_50
ds_read_b128 v[168:171], v115 offset:3072
buffer_load_dword v126, v112, s[24:27], s91 offen
s_branch L_w7e_51
L_w7g_50:
buffer_load_dwordx4 v[168:171], v112, s[24:27], s91 offen offset:3072
L_w7e_51:
s_waitcnt vmcnt(15)
v_mfma_f32_16x16x32_bf16 v[56:59], v[188:191], v[108:111], v[56:59]
v_mfma_f32_16x16x32_bf16 v[60:63], v[192:195], v[108:111], v[60:63]
v_mfma_f32_16x16x32_bf16 v[64:67], v[196:199], v[108:111], v[64:67]
v_mfma_f32_16x16x32_bf16 v[68:71], v[200:203], v[108:111], v[68:71]
v_mfma_f32_16x16x32_bf16 v[72:75], v[204:207], v[108:111], v[72:75]
s_cmp_eq_u32 s93, 0
s_cbranch_scc1 L_w7g_52
v_add_u32 v115, s92, v115
ds_read_b128 v[172:175], v115 offset:0
buffer_load_dword v126, v112, s[24:27], s91 offen
s_branch L_w7e_53
L_w7g_52:
s_add_u32 s91, s91, 4096
buffer_load_dwordx4 v[172:175], v112, s[24:27], s91 offen
L_w7e_53:
s_waitcnt vmcnt(15)
v_mfma_f32_16x16x32_bf16 v[76:79], v[188:191], v[248:251], v[76:79]
buffer_load_dwordx4 v[176:179], v112, s[24:27], s44 offen
v_mfma_f32_16x16x32_bf16 v[80:83], v[192:195], v[248:251], v[80:83]
v_mfma_f32_16x16x32_bf16 v[84:87], v[196:199], v[248:251], v[84:87]
v_mfma_f32_16x16x32_bf16 v[88:91], v[200:203], v[248:251], v[88:91]
v_mfma_f32_16x16x32_bf16 v[92:95], v[204:207], v[248:251], v[92:95]
s_waitcnt vmcnt(15)
v_mfma_f32_16x16x32_bf16 v[16:19], v[208:211], v[252:255], v[16:19]
v_mfma_f32_16x16x32_bf16 v[20:23], v[212:215], v[252:255], v[20:23]
v_mfma_f32_16x16x32_bf16 v[24:27], v[216:219], v[252:255], v[24:27]
v_mfma_f32_16x16x32_bf16 v[28:31], v[220:223], v[252:255], v[28:31]
v_mfma_f32_16x16x32_bf16 v[32:35], v[224:227], v[252:255], v[32:35]
buffer_load_dwordx4 v[180:183], v112, s[24:27], s45 offen
s_waitcnt vmcnt(15)
v_mfma_f32_16x16x32_bf16 v[36:39], v[208:211], v[96:99], v[36:39]
v_mfma_f32_16x16x32_bf16 v[40:43], v[212:215], v[96:99], v[40:43]
v_mfma_f32_16x16x32_bf16 v[44:47], v[216:219], v[96:99], v[44:47]
v_mfma_f32_16x16x32_bf16 v[48:51], v[220:223], v[96:99], v[48:51]
v_mfma_f32_16x16x32_bf16 v[52:55], v[224:227], v[96:99], v[52:55]
buffer_load_dwordx4 v[184:187], v112, s[24:27], s46 offen
s_waitcnt vmcnt(15)
v_mfma_f32_16x16x32_bf16 v[56:59], v[208:211], v[148:151], v[56:59]
v_mfma_f32_16x16x32_bf16 v[60:63], v[212:215], v[148:151], v[60:63]
v_mfma_f32_16x16x32_bf16 v[64:67], v[216:219], v[148:151], v[64:67]
v_mfma_f32_16x16x32_bf16 v[68:71], v[220:223], v[148:151], v[68:71]
v_mfma_f32_16x16x32_bf16 v[72:75], v[224:227], v[148:151], v[72:75]
buffer_load_dwordx4 v[136:139], v112, s[24:27], s47 offen
s_waitcnt vmcnt(15)
v_mfma_f32_16x16x32_bf16 v[76:79], v[208:211], v[152:155], v[76:79]
v_mfma_f32_16x16x32_bf16 v[80:83], v[212:215], v[152:155], v[80:83]
v_mfma_f32_16x16x32_bf16 v[84:87], v[216:219], v[152:155], v[84:87]
v_mfma_f32_16x16x32_bf16 v[88:91], v[220:223], v[152:155], v[88:91]
v_mfma_f32_16x16x32_bf16 v[92:95], v[224:227], v[152:155], v[92:95]
s_waitcnt vmcnt(12)
s_cmp_ge_u32 s3, 4
s_cbranch_scc1 L_g2_nz

v_cmp_ne_u32 vcc, s6, v116
v_cmp_ne_u32_e64 s[100:101], s6, v117
s_or_b64 vcc, vcc, s[100:101]
s_cmp_eq_u64 vcc, 0

s_cbranch_scc0 L_g2_nz
v_lshrrev_b32 v120, 1, v1
v_lshlrev_b32 v120, 12, v120
v_and_b32 v14, 1, v1
v_lshl_add_u32 v120, v14, 4, v120
s_mul_i32 s100, s37, 327680
s_lshl_b32 s101, s87, 1
s_add_u32 s100, s100, s101
s_add_u32 s100, s100, 7864320
s_add_u32 m0, s98, 20480

s_nop 0
buffer_load_dwordx4 v120, s[24:27], s100 offen sc1 lds
s_add_u32 m0, m0, 1024
s_add_u32 s100, s100, 131072
buffer_load_dwordx4 v120, s[24:27], s100 offen sc1 lds
s_add_u32 m0, m0, 1024
s_add_u32 s100, s100, 131072
s_mov_b32 exec_hi, 0
buffer_load_dwordx4 v120, s[24:27], s100 offen sc1 lds
s_mov_b32 exec_hi, -1
s_mov_b32 s90, 1
L_g2_nz:
v_mfma_f32_16x16x32_bf16 v[16:19], v[228:231], v[156:159], v[16:19]
v_mfma_f32_16x16x32_bf16 v[20:23], v[232:235], v[156:159], v[20:23]
v_mfma_f32_16x16x32_bf16 v[24:27], v[236:239], v[156:159], v[24:27]
v_mfma_f32_16x16x32_bf16 v[28:31], v[240:243], v[156:159], v[28:31]
v_mfma_f32_16x16x32_bf16 v[32:35], v[244:247], v[156:159], v[32:35]
s_waitcnt vmcnt(11)
v_mfma_f32_16x16x32_bf16 v[36:39], v[228:231], v[160:163], v[36:39]
v_mfma_f32_16x16x32_bf16 v[40:43], v[232:235], v[160:163], v[40:43]
v_mfma_f32_16x16x32_bf16 v[44:47], v[236:239], v[160:163], v[44:47]
v_mfma_f32_16x16x32_bf16 v[48:51], v[240:243], v[160:163], v[48:51]
v_mfma_f32_16x16x32_bf16 v[52:55], v[244:247], v[160:163], v[52:55]
s_waitcnt vmcnt(10)
v_mfma_f32_16x16x32_bf16 v[56:59], v[228:231], v[164:167], v[56:59]
v_mfma_f32_16x16x32_bf16 v[60:63], v[232:235], v[164:167], v[60:63]
v_mfma_f32_16x16x32_bf16 v[64:67], v[236:239], v[164:167], v[64:67]
v_mfma_f32_16x16x32_bf16 v[68:71], v[240:243], v[164:167], v[68:71]
v_mfma_f32_16x16x32_bf16 v[72:75], v[244:247], v[164:167], v[72:75]
s_waitcnt vmcnt(9)
v_mfma_f32_16x16x32_bf16 v[76:79], v[228:231], v[100:103], v[76:79]
v_mfma_f32_16x16x32_bf16 v[80:83], v[232:235], v[100:103], v[80:83]
v_mfma_f32_16x16x32_bf16 v[84:87], v[236:239], v[100:103], v[84:87]
v_mfma_f32_16x16x32_bf16 v[88:91], v[240:243], v[100:103], v[88:91]
v_mfma_f32_16x16x32_bf16 v[92:95], v[244:247], v[100:103], v[92:95]
s_waitcnt vmcnt(3)
v_mov_b32 v14, 163264
s_mov_b32 s74, 65536
L_xw_54:
ds_read_b128 v[140:143], v14
ds_read_b128 v[144:147], v14 offset:16
s_waitcnt lgkmcnt(0)
v_min_u32 v140, v140, v141
v_min3_u32 v140, v140, v142, v143
v_min3_u32 v140, v140, v144, v145
v_min3_u32 v140, v140, v146, v147
s_nop 0
v_readfirstlane_b32 s100, v140
s_cmp_ge_u32 s100, 1000
s_cbranch_scc1 L_xwd_55
s_sleep 1
s_sub_u32 s74, s74, 1
s_cmp_lg_u32 s74, 0
s_cbranch_scc1 L_xw_54
L_xwd_55:

v_mfma_f32_16x16x32_bf16 v[16:19], v[104:107], v[176:179], v[16:19]
v_mfma_f32_16x16x32_bf16 v[20:23], v[128:131], v[176:179], v[20:23]
v_mfma_f32_16x16x32_bf16 v[24:27], v[132:135], v[176:179], v[24:27]
v_mfma_f32_16x16x32_bf16 v[28:31], v[168:171], v[176:179], v[28:31]
v_mfma_f32_16x16x32_bf16 v[32:35], v[172:175], v[176:179], v[32:35]
s_waitcnt vmcnt(2)
v_mfma_f32_16x16x32_bf16 v[36:39], v[104:107], v[180:183], v[36:39]
v_mfma_f32_16x16x32_bf16 v[40:43], v[128:131], v[180:183], v[40:43]
v_mfma_f32_16x16x32_bf16 v[44:47], v[132:135], v[180:183], v[44:47]
v_mfma_f32_16x16x32_bf16 v[48:51], v[168:171], v[180:183], v[48:51]
v_mfma_f32_16x16x32_bf16 v[52:55], v[172:175], v[180:183], v[52:55]
ds_write_b128 v121, v[16:19] offset:0
ds_write_b128 v121, v[20:23] offset:1024
ds_write_b128 v121, v[24:27] offset:2048
ds_write_b128 v121, v[28:31] offset:3072
ds_write_b128 v121, v[32:35] offset:4096
s_waitcnt vmcnt(1)
v_mfma_f32_16x16x32_bf16 v[56:59], v[104:107], v[184:187], v[56:59]
v_mfma_f32_16x16x32_bf16 v[60:63], v[128:131], v[184:187], v[60:63]
v_mfma_f32_16x16x32_bf16 v[64:67], v[132:135], v[184:187], v[64:67]
v_mfma_f32_16x16x32_bf16 v[68:71], v[168:171], v[184:187], v[68:71]
v_mfma_f32_16x16x32_bf16 v[72:75], v[172:175], v[184:187], v[72:75]
ds_write_b128 v122, v[36:39] offset:0
ds_write_b128 v122, v[40:43] offset:1024
ds_write_b128 v122, v[44:47] offset:2048
ds_write_b128 v122, v[48:51] offset:3072
ds_write_b128 v122, v[52:55] offset:4096
s_waitcnt vmcnt(0)
v_mfma_f32_16x16x32_bf16 v[76:79], v[104:107], v[136:139], v[76:79]
v_mfma_f32_16x16x32_bf16 v[80:83], v[128:131], v[136:139], v[80:83]
v_mfma_f32_16x16x32_bf16 v[84:87], v[132:135], v[136:139], v[84:87]
v_mfma_f32_16x16x32_bf16 v[88:91], v[168:171], v[136:139], v[88:91]
v_mfma_f32_16x16x32_bf16 v[92:95], v[172:175], v[136:139], v[92:95]
ds_write_b128 v123, v[56:59] offset:0
ds_write_b128 v123, v[60:63] offset:1024
ds_write_b128 v123, v[64:67] offset:2048
ds_write_b128 v123, v[68:71] offset:3072
ds_write_b128 v123, v[72:75] offset:4096
s_cmp_lt_u32 s3, 4
s_cbranch_scc1 L_g2_c

ds_write_b128 v124, v[76:79] offset:0
ds_write_b128 v124, v[80:83] offset:1024
ds_write_b128 v124, v[84:87] offset:2048
ds_write_b128 v124, v[88:91] offset:3072
ds_write_b128 v124, v[92:95] offset:4096
s_waitcnt lgkmcnt(0)
s_barrier
s_branch L_end
L_g2_c:
s_lshl_b32 s100, s3, 2
s_add_u32 s100, s100, 162208
v_mov_b32 v14, s100
s_waitcnt lgkmcnt(0)
ds_write_b32 v14, v14

s_cmp_lg_u32 s90, 0
s_cbranch_scc1 L_g2_zd
s_mov_b32 s74, 8192
L_zp_56:
buffer_load_dword v116, v15, s[24:27], s96 offen sc1
buffer_load_dword v117, v125, s[24:27], s96 offen sc1
s_waitcnt vmcnt(0)

v_cmp_ne_u32 vcc, s6, v116
v_cmp_ne_u32_e64 s[100:101], s6, v117
s_or_b64 vcc, vcc, s[100:101]
s_cmp_eq_u64 vcc, 0

s_cbranch_scc1 L_zpd_57
s_sub_u32 s74, s74, 1
s_cmp_lg_u32 s74, 0
s_cbranch_scc1 L_zp_56
L_zpd_57:

v_lshrrev_b32 v120, 1, v1
v_lshlrev_b32 v120, 12, v120
v_and_b32 v14, 1, v1
v_lshl_add_u32 v120, v14, 4, v120
s_mul_i32 s100, s37, 327680
s_lshl_b32 s101, s87, 1
s_add_u32 s100, s100, s101
s_add_u32 s100, s100, 7864320
s_add_u32 m0, s98, 20480

s_nop 0
buffer_load_dwordx4 v120, s[24:27], s100 offen sc1 lds
s_add_u32 m0, m0, 1024
s_add_u32 s100, s100, 131072
buffer_load_dwordx4 v120, s[24:27], s100 offen sc1 lds
s_add_u32 m0, m0, 1024
s_add_u32 s100, s100, 131072
s_mov_b32 exec_hi, 0
buffer_load_dwordx4 v120, s[24:27], s100 offen sc1 lds
s_mov_b32 exec_hi, -1
L_g2_zd:
v_add_u32 v120, s87, v2
v_lshlrev_b32 v120, 3, v120
s_mov_b32 s74, 8192
s_mov_b32 s100, 17563648
L_sp_58:
v_cmp_ne_u32 vcc, s6, v119
s_cmp_eq_u64 vcc, 0
s_cbranch_scc1 L_spd_59
buffer_load_dwordx2 v[118:119], v120, s[24:27], s100 offen sc1
s_waitcnt vmcnt(0)
s_sub_u32 s74, s74, 1
s_cmp_lg_u32 s74, 0
s_cbranch_scc1 L_sp_58
L_spd_59:
v_and_b32 v119, 0xffff0000, v118
v_lshlrev_b32 v118, 16, v118
v_rcp_f32 v119, v119
s_mul_i32 s100, s3, 15360
s_add_u32 s100, s100, 98304
v_add_u32 v14, s100, v112
s_mul_i32 s100, s3, 5120
v_add_u32 v15, s100, v112
v_add_u32 v125, 49152, v15
v_mov_b32 v126, 162208
s_mov_b32 s74, 65536
L_cs_60:
ds_read_b128 v[96:99], v126
s_waitcnt lgkmcnt(0)
v_min_u32 v96, v96, v97
v_min3_u32 v96, v96, v98, v99
s_nop 0
v_readfirstlane_b32 s100, v96
s_cmp_lg_u32 s100, 0
s_cbranch_scc1 L_csd_61
s_sleep 1
s_sub_u32 s74, s74, 1
s_cmp_lg_u32 s74, 0
s_cbranch_scc1 L_cs_60
L_csd_61:

ds_read_b128 v[128:131], v14 offset:0
ds_read_b128 v[132:135], v14 offset:1024
ds_read_b128 v[136:139], v14 offset:2048
ds_read_b128 v[140:143], v14 offset:3072
ds_read_b128 v[144:147], v14 offset:4096
ds_read_b128 v[148:151], v14 offset:5120
ds_read_b128 v[152:155], v14 offset:6144
ds_read_b128 v[156:159], v14 offset:7168
ds_read_b128 v[160:163], v14 offset:8192
ds_read_b128 v[164:167], v14 offset:9216
ds_read_b128 v[168:171], v14 offset:10240
ds_read_b128 v[172:175], v14 offset:11264
ds_read_b128 v[176:179], v14 offset:12288
ds_read_b128 v[180:183], v14 offset:13312
ds_read_b128 v[184:187], v14 offset:14336
s_waitcnt lgkmcnt(10)
v_pk_add_f32 v[76:77], v[76:77], v[128:129]
v_pk_add_f32 v[78:79], v[78:79], v[130:131]
v_pk_add_f32 v[80:81], v[80:81], v[132:133]
v_pk_add_f32 v[82:83], v[82:83], v[134:135]
v_pk_add_f32 v[84:85], v[84:85], v[136:137]
v_pk_add_f32 v[86:87], v[86:87], v[138:139]
v_pk_add_f32 v[88:89], v[88:89], v[140:141]
v_pk_add_f32 v[90:91], v[90:91], v[142:143]
v_pk_add_f32 v[92:93], v[92:93], v[144:145]
v_pk_add_f32 v[94:95], v[94:95], v[146:147]
s_waitcnt lgkmcnt(5)
v_pk_add_f32 v[76:77], v[76:77], v[148:149]
v_pk_add_f32 v[78:79], v[78:79], v[150:151]
v_pk_add_f32 v[80:81], v[80:81], v[152:153]
v_pk_add_f32 v[82:83], v[82:83], v[154:155]
v_pk_add_f32 v[84:85], v[84:85], v[156:157]
v_pk_add_f32 v[86:87], v[86:87], v[158:159]
v_pk_add_f32 v[88:89], v[88:89], v[160:161]
v_pk_add_f32 v[90:91], v[90:91], v[162:163]
v_pk_add_f32 v[92:93], v[92:93], v[164:165]
v_pk_add_f32 v[94:95], v[94:95], v[166:167]
s_waitcnt lgkmcnt(0)
v_pk_add_f32 v[76:77], v[76:77], v[168:169]
v_pk_add_f32 v[78:79], v[78:79], v[170:171]
v_pk_add_f32 v[80:81], v[80:81], v[172:173]
v_pk_add_f32 v[82:83], v[82:83], v[174:175]
v_pk_add_f32 v[84:85], v[84:85], v[176:177]
v_pk_add_f32 v[86:87], v[86:87], v[178:179]
v_pk_add_f32 v[88:89], v[88:89], v[180:181]
v_pk_add_f32 v[90:91], v[90:91], v[182:183]
v_pk_add_f32 v[92:93], v[92:93], v[184:185]
v_pk_add_f32 v[94:95], v[94:95], v[186:187]
v_lshlrev_b32 v16, 7, v3
v_sub_u32 v16, v114, v16
v_lshlrev_b32 v17, 3, v3
v_sub_u32 v17, v113, v17
s_mov_b32 s74, 8192
L_g2_zq:
s_waitcnt vmcnt(0)
ds_read_b64_tr_b16 v[40:41], v114 offset:0
ds_read_b64_tr_b16 v[42:43], v114 offset:128
ds_read_b64_tr_b16 v[44:45], v114 offset:1024
ds_read_b64_tr_b16 v[46:47], v114 offset:1152
ds_read_b64_tr_b16 v[48:49], v16 offset:2048
s_waitcnt lgkmcnt(3)
v_pk_max_u16 v52, v40, v41
v_pk_max_u16 v53, v42, v43
s_waitcnt lgkmcnt(1)
v_pk_max_u16 v54, v44, v45
v_pk_max_u16 v55, v46, v47
v_pk_max_u16 v52, v52, v53
s_waitcnt lgkmcnt(0)
v_pk_max_u16 v53, v48, v49
v_pk_max_u16 v54, v54, v55
v_pk_max_u16 v52, v52, v53
v_pk_max_u16 v52, v52, v54
v_pk_max_u16 v52, v52, v52 op_sel:[0,1] op_sel_hi:[1,0]
v_cmp_eq_u32 vcc, -1, v52
s_cmp_eq_u64 vcc, 0
s_cbranch_scc1 L_g2_zok
s_sub_u32 s74, s74, 1
s_cmp_eq_u32 s74, 0
s_cbranch_scc1 L_g2_zok

v_lshrrev_b32 v120, 1, v1
v_lshlrev_b32 v120, 12, v120
v_and_b32 v14, 1, v1
v_lshl_add_u32 v120, v14, 4, v120
s_mul_i32 s100, s37, 327680
s_lshl_b32 s101, s87, 1
s_add_u32 s100, s100, s101
s_add_u32 s100, s100, 7864320
s_add_u32 m0, s98, 20480

s_nop 0
buffer_load_dwordx4 v120, s[24:27], s100 offen sc1 lds
s_add_u32 m0, m0, 1024
s_add_u32 s100, s100, 131072
buffer_load_dwordx4 v120, s[24:27], s100 offen sc1 lds
s_add_u32 m0, m0, 1024
s_add_u32 s100, s100, 131072
s_mov_b32 exec_hi, 0
buffer_load_dwordx4 v120, s[24:27], s100 offen sc1 lds
s_mov_b32 exec_hi, -1
s_branch L_g2_zq
L_g2_zok:
v_lshlrev_b32 v52, 16, v4
v_and_b32 v53, 0xffff0000, v4
v_lshlrev_b32 v54, 16, v40
v_and_b32 v55, 0xffff0000, v40
v_add_f32 v76, v76, v52
v_add_f32 v77, v77, v53
v_sub_f32 v52, v52, v118
v_sub_f32 v53, v53, v118
v_mul_f32 v54, v54, v119
v_mul_f32 v55, v55, v119
v_fmac_f32 v76, v52, v54
v_fmac_f32 v77, v53, v55

v_lshlrev_b32 v52, 16, v5
v_and_b32 v53, 0xffff0000, v5
v_lshlrev_b32 v54, 16, v41
v_and_b32 v55, 0xffff0000, v41
v_add_f32 v78, v78, v52
v_add_f32 v79, v79, v53
v_sub_f32 v52, v52, v118
v_sub_f32 v53, v53, v118
v_mul_f32 v54, v54, v119
v_mul_f32 v55, v55, v119
v_fmac_f32 v78, v52, v54
v_fmac_f32 v79, v53, v55

v_lshlrev_b32 v52, 16, v6
v_and_b32 v53, 0xffff0000, v6
v_lshlrev_b32 v54, 16, v42
v_and_b32 v55, 0xffff0000, v42
v_add_f32 v80, v80, v52
v_add_f32 v81, v81, v53
v_sub_f32 v52, v52, v118
v_sub_f32 v53, v53, v118
v_mul_f32 v54, v54, v119
v_mul_f32 v55, v55, v119
v_fmac_f32 v80, v52, v54
v_fmac_f32 v81, v53, v55

v_lshlrev_b32 v52, 16, v7
v_and_b32 v53, 0xffff0000, v7
v_lshlrev_b32 v54, 16, v43
v_and_b32 v55, 0xffff0000, v43
v_add_f32 v82, v82, v52
v_add_f32 v83, v83, v53
v_sub_f32 v52, v52, v118
v_sub_f32 v53, v53, v118
v_mul_f32 v54, v54, v119
v_mul_f32 v55, v55, v119
v_fmac_f32 v82, v52, v54
v_fmac_f32 v83, v53, v55

v_lshlrev_b32 v52, 16, v8
v_and_b32 v53, 0xffff0000, v8
v_lshlrev_b32 v54, 16, v44
v_and_b32 v55, 0xffff0000, v44
v_add_f32 v84, v84, v52
v_add_f32 v85, v85, v53
v_sub_f32 v52, v52, v118
v_sub_f32 v53, v53, v118
v_mul_f32 v54, v54, v119
v_mul_f32 v55, v55, v119
v_fmac_f32 v84, v52, v54
v_fmac_f32 v85, v53, v55

v_lshlrev_b32 v52, 16, v9
v_and_b32 v53, 0xffff0000, v9
v_lshlrev_b32 v54, 16, v45
v_and_b32 v55, 0xffff0000, v45
v_add_f32 v86, v86, v52
v_add_f32 v87, v87, v53
v_sub_f32 v52, v52, v118
v_sub_f32 v53, v53, v118
v_mul_f32 v54, v54, v119
v_mul_f32 v55, v55, v119
v_fmac_f32 v86, v52, v54
v_fmac_f32 v87, v53, v55

v_lshlrev_b32 v52, 16, v10
v_and_b32 v53, 0xffff0000, v10
v_lshlrev_b32 v54, 16, v46
v_and_b32 v55, 0xffff0000, v46
v_add_f32 v88, v88, v52
v_add_f32 v89, v89, v53
v_sub_f32 v52, v52, v118
v_sub_f32 v53, v53, v118
v_mul_f32 v54, v54, v119
v_mul_f32 v55, v55, v119
v_fmac_f32 v88, v52, v54
v_fmac_f32 v89, v53, v55

v_lshlrev_b32 v52, 16, v11
v_and_b32 v53, 0xffff0000, v11
v_lshlrev_b32 v54, 16, v47
v_and_b32 v55, 0xffff0000, v47
v_add_f32 v90, v90, v52
v_add_f32 v91, v91, v53
v_sub_f32 v52, v52, v118
v_sub_f32 v53, v53, v118
v_mul_f32 v54, v54, v119
v_mul_f32 v55, v55, v119
v_fmac_f32 v90, v52, v54
v_fmac_f32 v91, v53, v55

v_lshlrev_b32 v52, 16, v12
v_and_b32 v53, 0xffff0000, v12
v_lshlrev_b32 v54, 16, v48
v_and_b32 v55, 0xffff0000, v48
v_add_f32 v92, v92, v52
v_add_f32 v93, v93, v53
v_sub_f32 v52, v52, v118
v_sub_f32 v53, v53, v118
v_mul_f32 v54, v54, v119
v_mul_f32 v55, v55, v119
v_fmac_f32 v92, v52, v54
v_fmac_f32 v93, v53, v55

v_lshlrev_b32 v52, 16, v13
v_and_b32 v53, 0xffff0000, v13
v_lshlrev_b32 v54, 16, v49
v_and_b32 v55, 0xffff0000, v49
v_add_f32 v94, v94, v52
v_add_f32 v95, v95, v53
v_sub_f32 v52, v52, v118
v_sub_f32 v53, v53, v118
v_mul_f32 v54, v54, v119
v_mul_f32 v55, v55, v119
v_fmac_f32 v94, v52, v54
v_fmac_f32 v95, v53, v55

s_barrier
ds_read_b128 v[128:131], v15 offset:0
ds_read_b128 v[148:151], v15 offset:24576
ds_read_b128 v[168:171], v125 offset:0
ds_read_b128 v[188:191], v125 offset:24576
ds_read_b128 v[132:135], v15 offset:1024
ds_read_b128 v[152:155], v15 offset:25600
ds_read_b128 v[172:175], v125 offset:1024
ds_read_b128 v[192:195], v125 offset:25600
ds_read_b128 v[136:139], v15 offset:2048
ds_read_b128 v[156:159], v15 offset:26624
ds_read_b128 v[176:179], v125 offset:2048
ds_read_b128 v[196:199], v125 offset:26624
ds_read_b128 v[140:143], v15 offset:3072
ds_read_b128 v[160:163], v15 offset:27648
ds_read_b128 v[180:183], v125 offset:3072
ds_read_b128 v[200:203], v125 offset:27648
ds_read_b128 v[144:147], v15 offset:4096
ds_read_b128 v[164:167], v15 offset:28672
ds_read_b128 v[184:187], v125 offset:4096
ds_read_b128 v[204:207], v125 offset:28672
s_waitcnt lgkmcnt(15)
v_pk_add_f32 v[128:129], v[128:129], v[148:149]
v_pk_add_f32 v[168:169], v[168:169], v[188:189]
v_pk_add_f32 v[76:77], v[76:77], v[128:129]
v_pk_add_f32 v[76:77], v[76:77], v[168:169]
v_cvt_pk_bf16_f32 v4, v76, v77
v_pk_add_f32 v[130:131], v[130:131], v[150:151]
v_pk_add_f32 v[170:171], v[170:171], v[190:191]
v_pk_add_f32 v[78:79], v[78:79], v[130:131]
v_pk_add_f32 v[78:79], v[78:79], v[170:171]
v_cvt_pk_bf16_f32 v5, v78, v79
s_waitcnt lgkmcnt(12)
v_pk_add_f32 v[132:133], v[132:133], v[152:153]
v_pk_add_f32 v[172:173], v[172:173], v[192:193]
v_pk_add_f32 v[80:81], v[80:81], v[132:133]
v_pk_add_f32 v[80:81], v[80:81], v[172:173]
v_cvt_pk_bf16_f32 v6, v80, v81
v_pk_add_f32 v[134:135], v[134:135], v[154:155]
v_pk_add_f32 v[174:175], v[174:175], v[194:195]
v_pk_add_f32 v[82:83], v[82:83], v[134:135]
v_pk_add_f32 v[82:83], v[82:83], v[174:175]
v_cvt_pk_bf16_f32 v7, v82, v83
buffer_store_dwordx4 v[4:7], v113, s[16:19], 0 offen offset:0
s_waitcnt lgkmcnt(8)
v_pk_add_f32 v[136:137], v[136:137], v[156:157]
v_pk_add_f32 v[176:177], v[176:177], v[196:197]
v_pk_add_f32 v[84:85], v[84:85], v[136:137]
v_pk_add_f32 v[84:85], v[84:85], v[176:177]
v_cvt_pk_bf16_f32 v8, v84, v85
v_pk_add_f32 v[138:139], v[138:139], v[158:159]
v_pk_add_f32 v[178:179], v[178:179], v[198:199]
v_pk_add_f32 v[86:87], v[86:87], v[138:139]
v_pk_add_f32 v[86:87], v[86:87], v[178:179]
v_cvt_pk_bf16_f32 v9, v86, v87
s_waitcnt lgkmcnt(4)
v_pk_add_f32 v[140:141], v[140:141], v[160:161]
v_pk_add_f32 v[180:181], v[180:181], v[200:201]
v_pk_add_f32 v[88:89], v[88:89], v[140:141]
v_pk_add_f32 v[88:89], v[88:89], v[180:181]
v_cvt_pk_bf16_f32 v10, v88, v89
v_pk_add_f32 v[142:143], v[142:143], v[162:163]
v_pk_add_f32 v[182:183], v[182:183], v[202:203]
v_pk_add_f32 v[90:91], v[90:91], v[142:143]
v_pk_add_f32 v[90:91], v[90:91], v[182:183]
v_cvt_pk_bf16_f32 v11, v90, v91
buffer_store_dwordx4 v[8:11], v113, s[16:19], 0 offen offset:64
s_waitcnt lgkmcnt(0)
v_pk_add_f32 v[144:145], v[144:145], v[164:165]
v_pk_add_f32 v[184:185], v[184:185], v[204:205]
v_pk_add_f32 v[92:93], v[92:93], v[144:145]
v_pk_add_f32 v[92:93], v[92:93], v[184:185]
v_cvt_pk_bf16_f32 v12, v92, v93
v_pk_add_f32 v[146:147], v[146:147], v[166:167]
v_pk_add_f32 v[186:187], v[186:187], v[206:207]
v_pk_add_f32 v[94:95], v[94:95], v[146:147]
v_pk_add_f32 v[94:95], v[94:95], v[186:187]
v_cvt_pk_bf16_f32 v13, v94, v95
buffer_store_dwordx2 v[12:13], v17, s[16:19], 0 offen offset:128
s_branch L_end
L_end:
s_endpgm
.section .rodata,"a"
.p2align 6
.amdhsa_kernel fused_kernel
  .amdhsa_next_free_vgpr 256
  .amdhsa_next_free_sgpr 102
  .amdhsa_accum_offset 256
  .amdhsa_group_segment_fixed_size 0
  .amdhsa_kernarg_size 104
  .amdhsa_user_sgpr_count 2
  .amdhsa_user_sgpr_kernarg_segment_ptr 1
  .amdhsa_system_sgpr_workgroup_id_x 1
.end_amdhsa_kernel
```
